```python
import torch

def _softmax(x, axis=-1):
    return torch.softmax(x, dim=axis)
def _gelu(x):
    return torch.nn.functional.gelu(x, approximate="tanh")
def _silu(x):
    return torch.nn.functional.silu(x)
def _sigmoid(x):
    return torch.sigmoid(x)
def _layernorm(x, axis=-1, eps=1e-5):
    m = x.mean(dim=axis, keepdim=True)
    v = x.var(dim=axis, keepdim=True, unbiased=False)
    return (x - m) / torch.sqrt(v + eps)
def _scatter_add(tgt, idx, src, axis=0):
    return tgt.clone().index_add_(axis, idx, src)
def _segment_sum(src, seg, n):
    out = torch.zeros((n,) + src.shape[1:], dtype=src.dtype)
    return out.index_add_(0, seg, src)
def _pad(x, pw):
    flat = tuple(v for pair in reversed(pw) for v in pair)
    return torch.nn.functional.pad(x, flat)

kernel_name = 'sequential_preLN__sliding_block_cached__geglu_ffn__decode'

def setup_inputs():

    _w = (lambda a: (lambda t: t.to(torch.bfloat16) if t.is_floating_point() else t)(torch.as_tensor(a)))
    def _A_setup():
        B, Sq, D = 1, 1, 448
        Hq, Hkv, Sk, Dh = 16, 8, 16384, 256
        assert Hq % Hkv == 0, (Hq, Hkv)
        return {
            "x": _w((lambda *s: torch.randn(*s, dtype=torch.bfloat16) * 0.05)(B, Sq, D)),
            "k_cache": _w((lambda *s: torch.randn(*s, dtype=torch.bfloat16) * 3.2)(B, Hkv, Sk, Dh)),
            "v_cache": _w((lambda *s: torch.randn(*s, dtype=torch.bfloat16) * 0.4)(B, Hkv, Sk, Dh)),
            "wq": _w((lambda *s: torch.randn(*s, dtype=torch.bfloat16) * 3.2)(D, Hq * Dh) * (D ** -0.5)),
            "wo": _w((lambda *s: torch.randn(*s, dtype=torch.bfloat16) * 0.4)(Hq * Dh, D) * ((Hq * Dh) ** -0.5)),
        }
    _A_in = _A_setup()

    def _B_setup():
        B, S, D, F = 1, 1, 448, 1792
        return {
            "x": _w((lambda *s: torch.randn(*s, dtype=torch.bfloat16) * 0.05)(B, S, D)),
            "w_gate": _w((lambda *s: torch.randn(*s, dtype=torch.bfloat16) * 0.05)(D, F)),
            "w_up": _w((lambda *s: torch.randn(*s, dtype=torch.bfloat16) * 0.05)(D, F)),
            "w_down": _w((lambda *s: torch.randn(*s, dtype=torch.bfloat16) * 0.05)(F, D)),
        }
    _B_in = _B_setup()

    return {
        "A_x": _A_in["x"],
        "A_k_cache": _A_in["k_cache"],
        "A_v_cache": _A_in["v_cache"],
        "A_wq": _A_in["wq"],
        "A_wo": _A_in["wo"],
        "B_x": _B_in["x"],
        "B_w_gate": _B_in["w_gate"],
        "B_w_up": _B_in["w_up"],
        "B_w_down": _B_in["w_down"],
    }

def reference(A_x, A_k_cache, A_v_cache, A_wq, A_wo, B_x, B_w_gate, B_w_up, B_w_down):
    def _A_ref(x, k_cache, v_cache, wq, wo):
        B, Sq, D = x.shape
        Hq, Dh = 16, 256
        Hkv, Sk = k_cache.shape[1], k_cache.shape[2]
        W = min(4096, max(256, Sk // 4))
        rep = Hq // Hkv
        q = (lambda x, *d: x.permute(*d))((x @ wq).reshape(B, Sq, Hq, Dh), 0, 2, 1, 3)
        k = (lambda x, n, axis: torch.repeat_interleave(x, n, dim=axis))(k_cache[:, :, Sk - W:, :], rep, axis=1)
        v = (lambda x, n, axis: torch.repeat_interleave(x, n, dim=axis))(v_cache[:, :, Sk - W:, :], rep, axis=1)
        scores = torch.einsum("bhqd,bhkd->bhqk", q, k) * (Dh ** -0.5)
        p = _softmax(scores, axis=-1)
        o = torch.einsum("bhqk,bhkd->bhqd", p, v)
        return (lambda x, *d: x.permute(*d))(o, 0, 2, 1, 3).reshape(B, Sq, Hq * Dh) @ wo

    def _B_ref(x, w_gate, w_up, w_down):
        return (_gelu(x @ w_gate) * (x @ w_up)) @ w_down

    x = A_x
    h = x + _A_ref(_layernorm(x, axis=-1), A_k_cache, A_v_cache, A_wq, A_wo)
    h2 = h + _B_ref(_layernorm(h, axis=-1), B_w_gate, B_w_up, B_w_down)
    return h2
```

```asm
; @launch grid=(256,1,1) block=(320,1,1) lds=14336
.amdgcn_target "amdgcn-amd-amdhsa--gfx950"
.text
.globl sequential_preLN__sliding_block_cached__geglu_ffn__decode_kernel
.p2align 12
.fill 832, 4, 0xbf800000
.p2align 8
.type sequential_preLN__sliding_block_cached__geglu_ffn__decode_kernel,@function
sequential_preLN__sliding_block_cached__geglu_ffn__decode_kernel:
    s_cmp_ge_u32 s2, 256
    s_cbranch_scc1 L_exit
    s_load_dwordx16 s[4:19], s[0:1], 0
    s_load_dwordx8 s[20:27], s[0:1], 64
    v_lshrrev_b32 v1, 6, v0
    v_and_b32 v0, 63, v0
    v_readfirstlane_b32 s30, v1
    s_and_b32 s28, s2, 7
    s_lshr_b32 s29, s2, 3
    s_lshl_b32 s55, s28, 5
    s_add_u32 s55, s55, s29
    s_cmp_lg_u32 s30, 4
    s_cbranch_scc1 L_K
    s_setprio 3
    v_lshlrev_b32 v1, 4, v0
    v_lshrrev_b32 v2, 3, v0
    v_and_b32 v3, 7, v0
    v_mul_u32_u24 v4, 114688, v2
    v_lshl_add_u32 v4, v3, 4, v4
    s_lshr_b32 s49, s29, 2
    s_xor_b32 s49, s49, 4
    s_and_b32 s48, s29, 3
    s_mul_i32 s54, s48, 917504
    s_lshl_b32 s56, s28, 10
    s_add_u32 s54, s54, s56
    s_lshl_b32 s56, s49, 7
    s_add_u32 s54, s54, s56
    v_mov_b32 v6, 0
    v_mov_b32 v7, 1
    ds_write_b64 v1, v[6:7] offset:12032
    s_mov_b32 s42, 896
    s_mov_b32 s43, 0x00020000
    s_mov_b32 s38, 3670016
    s_mov_b32 s39, 0x00020000
    s_waitcnt lgkmcnt(0)
    s_mov_b64 s[40:41], s[4:5]
    buffer_load_dwordx4 v[8:11], v1, s[40:43], 0 offen
    s_mov_b64 s[36:37], s[10:11]
    buffer_load_dwordx4 v[16:19], v4, s[36:39], s54 offen nt
    s_add_u32 s54, s54, 8192
    buffer_load_dwordx4 v[20:23], v4, s[36:39], s54 offen nt
    s_add_u32 s54, s54, 8192
    buffer_load_dwordx4 v[24:27], v4, s[36:39], s54 offen nt
    s_add_u32 s54, s54, 8192
    buffer_load_dwordx4 v[28:31], v4, s[36:39], s54 offen nt
    s_add_u32 s54, s54, 8192
    buffer_load_dwordx4 v[32:35], v4, s[36:39], s54 offen nt
    s_add_u32 s54, s54, 8192
    buffer_load_dwordx4 v[36:39], v4, s[36:39], s54 offen nt
    s_add_u32 s54, s54, 8192
    buffer_load_dwordx4 v[40:43], v4, s[36:39], s54 offen nt
    s_add_u32 s54, s54, 8192
    buffer_load_dwordx4 v[44:47], v4, s[36:39], s54 offen nt
    s_add_u32 s54, s54, 8192
    buffer_load_dwordx4 v[48:51], v4, s[36:39], s54 offen nt
    s_add_u32 s54, s54, 8192
    buffer_load_dwordx4 v[52:55], v4, s[36:39], s54 offen nt
    s_add_u32 s54, s54, 8192
    buffer_load_dwordx4 v[56:59], v4, s[36:39], s54 offen nt
    s_add_u32 s54, s54, 8192
    buffer_load_dwordx4 v[60:63], v4, s[36:39], s54 offen nt
    s_add_u32 s54, s54, 8192
    buffer_load_dwordx4 v[64:67], v4, s[36:39], s54 offen nt
    s_add_u32 s54, s54, 8192
    buffer_load_dwordx4 v[68:71], v4, s[36:39], s54 offen nt
    s_load_dword s31, s[26:27], 0
    s_barrier
    s_branch L_Q1
L_qretry:
    s_sub_u32 s58, s58, 1
    s_cbranch_scc1 L_qdone
    s_and_b32 s56, s58, 3
    s_cbranch_scc0 L_qpub
L_qback:
    buffer_load_dwordx4 v[148:151], v4, s[32:35], s61 offen sc1
    buffer_load_dwordx4 v[152:155], v4, s[32:35], s62 offen sc1
    s_waitcnt vmcnt(0)
    s_branch L_qpoll
L_K:
    s_getpc_b64 s[48:49]
L_pc:
    s_lshl_b32 s56, s29, 2
    s_add_u32 s56, s56, s30
    s_lshl_b32 s56, s56, 7
    s_min_u32 s56, s56, L_exit-sequential_preLN__sliding_block_cached__geglu_ffn__decode_kernel
    s_sub_u32 s48, s48, L_pc-sequential_preLN__sliding_block_cached__geglu_ffn__decode_kernel
    s_subb_u32 s49, s49, 0
    v_mov_b32 v1, s56
    s_mov_b64 exec, 1
    global_load_dword v15, v1, s[48:49]
    s_mov_b64 exec, -1
    s_lshl_b32 s53, s28, 23
    s_lshl_b32 s54, s29, 15
    s_add_u32 s53, s53, s54
    s_add_u32 s53, s53, 6291456
    s_lshl_b32 s56, s28, 1
    s_xor_b32 s56, s56, s29
    s_and_b32 s56, s56, 15
    s_lshr_b32 s54, s56, 3
    s_lshl_b32 s54, s54, 20
    s_or_b32 s53, s53, s54
    s_and_b32 s54, s56, 7
    s_lshl_b32 s54, s54, 12
    s_or_b32 s53, s53, s54
    v_bfe_u32 v9, v0, 3, 1
    v_lshlrev_b32 v1, 9, v9
    v_lshrrev_b32 v2, 4, v0
    v_lshl_add_u32 v1, v2, 7, v1
    v_and_b32 v10, 7, v0
    v_lshl_add_u32 v1, v10, 4, v1
    s_lshl_b32 s54, s30, 10
    s_add_u32 s98, s54, s53
    s_mov_b32 s38, 67108864
    s_mov_b32 s39, 0x00020000
    s_waitcnt lgkmcnt(0)
    s_mov_b64 s[36:37], s[6:7]
    s_load_dword s31, s[26:27], 0
    s_barrier
    s_xor_b32 s54, s98, 0
    buffer_load_dwordx4 v[16:19], v1, s[36:39], s54 offen nt
    s_xor_b32 s54, s98, 4096
    buffer_load_dwordx4 v[20:23], v1, s[36:39], s54 offen nt
    s_xor_b32 s54, s98, 8192
    buffer_load_dwordx4 v[24:27], v1, s[36:39], s54 offen nt
    s_xor_b32 s54, s98, 12288
    buffer_load_dwordx4 v[28:31], v1, s[36:39], s54 offen nt
    s_xor_b32 s54, s98, 16384
    buffer_load_dwordx4 v[32:35], v1, s[36:39], s54 offen nt
    s_xor_b32 s54, s98, 20480
    buffer_load_dwordx4 v[36:39], v1, s[36:39], s54 offen nt
    s_xor_b32 s54, s98, 24576
    buffer_load_dwordx4 v[40:43], v1, s[36:39], s54 offen nt
    s_xor_b32 s54, s98, 28672
    buffer_load_dwordx4 v[44:47], v1, s[36:39], s54 offen nt
    s_mov_b64 s[32:33], s[26:27]
    s_mov_b32 s34, 2097152
    s_mov_b32 s35, 0x00020000
    s_mov_b64 s[40:41], s[12:13]
    s_mov_b32 s42, 3670016
    s_mov_b32 s43, 0x00020000
    s_mov_b64 s[44:45], s[8:9]
    s_mov_b32 s46, 67108864
    s_mov_b32 s47, 0x00020000
    s_mul_i32 s50, s29, 37
    s_lshr_b32 s50, s50, 8
    s_mul_i32 s51, s50, 7
    s_sub_u32 s51, s29, s51
    s_lshl_b32 s101, s28, 2
    s_lshr_b32 s101, 839939668, s101
    s_and_b32 s101, s101, 7
    s_lshl_b32 s52, s50, 3
    s_add_u32 s52, s52, s101
    s_mul_i32 s100, s101, 3
    s_min_u32 s101, s101, 4
    s_add_u32 s100, s100, s101
    s_add_u32 s100, s100, s50
    s_min_u32 s100, s100, 27
    v_and_b32 v7, 1, v0
    v_lshlrev_b32 v7, 4, v7
    v_mov_b32 v8, 0xffff
    v_lshlrev_b32 v8, v7, v8
    v_bfe_u32 v7, v0, 1, 2
    v_cmp_eq_u32 vcc, 0, v7
    s_nop 1
    v_cndmask_b32 v164, 0, v8, vcc
    v_cmp_eq_u32 vcc, 1, v7
    s_nop 1
    v_cndmask_b32 v165, 0, v8, vcc
    v_cmp_eq_u32 vcc, 2, v7
    s_nop 1
    v_cndmask_b32 v166, 0, v8, vcc
    v_cmp_eq_u32 vcc, 3, v7
    s_nop 1
    v_cndmask_b32 v167, 0, v8, vcc
    v_mov_b32 v246, 0
    v_mov_b32 v244, 0xff
    v_and_b32 v3, 3, v0
    v_lshrrev_b32 v5, 5, v0
    v_and_b32 v6, 31, v0
    v_lshlrev_b32 v4, 11, v5
    v_lshl_add_u32 v4, v6, 4, v4
    s_lshl_b32 s61, s28, 13
    s_lshl_b32 s62, s30, 9
    s_add_u32 s61, s61, s62
    s_add_u32 s61, s61, 65536
    s_add_u32 s62, s61, 4096
    v_lshlrev_b32 v6, 3, v6
    v_lshl_add_u32 v6, v5, 2, v6
    s_lshl_b32 s56, s30, 8
    v_add_u32 v6, s56, v6
    v_xor_b32 v7, 64, v1
    v_and_b32 v12, 15, v0
    v_lshlrev_b32 v228, 9, v2
    v_lshl_add_u32 v228, v12, 4, v228
    s_and_b32 s57, s30, 1
    s_lshr_b32 s60, s30, 1
    s_lshl_b32 s56, s57, 8
    s_add_u32 s99, s53, s56
    s_lshl_b32 s56, s60, 11
    s_add_u32 s99, s99, s56
    v_lshlrev_b32 v229, 10, v5
    v_and_b32 v13, 1, v2
    v_lshl_add_u32 v229, v13, 8, v229
    v_lshl_add_u32 v229, v12, 4, v229
    s_lshl_b32 s53, s55, 11
    s_lshl_b32 s56, s57, 9
    s_add_u32 s53, s53, s56
    s_add_u32 s53, s53, 262144
    s_lshl_b32 s56, s57, 10
    v_lshl_add_u32 v238, v0, 4, s56
    v_bfe_u32 v14, v0, 2, 1
    v_lshl_add_u32 v239, v5, 1, v9
    v_lshl_add_u32 v239, v14, 4, v239
    v_lshl_add_u32 v239, v13, 5, v239
    s_lshl_b32 s56, s30, 6
    v_lshl_add_u32 v239, v239, 4, s56
    s_lshl_b32 s56, s30, 2
    v_lshl_add_u32 v240, v9, 4, s56
    v_mov_b32 v243, s56
    v_lshrrev_b32 v241, 3, v0
    s_lshl_b32 s56, s60, 7
    v_lshl_add_u32 v241, v241, 4, s56
    v_lshlrev_b32 v242, 4, v9
    v_lshl_add_u32 v14, v2, 1, v14
    v_lshl_add_u32 v230, v14, 2, v3
    v_lshlrev_b32 v230, 4, v230
    v_lshlrev_b32 v231, 11, v14
    v_lshl_add_u32 v231, v9, 6, v231
    v_lshl_add_u32 v231, v3, 4, v231
    s_lshl_b32 s3, s28, 9
    s_add_u32 s3, s3, 131072
    v_lshlrev_b32 v232, 4, v13
    v_lshl_add_u32 v232, v10, 5, v232
    v_lshl_add_u32 v232, v9, 8, v232
    s_lshl_b32 s56, s30, 9
    v_add_u32 v232, s56, v232
    v_lshl_add_u32 v11, v9, 5, v2
    v_mul_u32_u24 v11, 896, v11
    v_lshl_add_u32 v11, v10, 4, v11
    s_lshl_b32 s48, s28, 9
    s_lshl_b32 s56, s50, 7
    s_add_u32 s48, s48, s56
    s_lshl_b32 s56, s57, 6
    s_add_u32 s48, s48, s56
    s_lshl_b32 s56, s60, 2
    s_add_u32 s48, s48, s56
    s_mul_i32 s48, s48, 896
    s_lshl_b32 s56, s51, 7
    s_add_u32 s48, s48, s56
    s_cmp_lt_u32 s29, 28
    s_cselect_b32 s42, s42, 0
    s_cselect_b32 s48, s48, 0
    s_lshl_b32 s49, s51, 6
    s_lshl_b32 s56, s30, 4
    s_add_u32 s49, s49, s56
    s_mul_i32 s63, s49, 3584
    s_lshl_b32 s56, s100, 7
    s_add_u32 s63, s63, s56
    v_mul_u32_u24 v12, 3584, v2
    v_lshl_add_u32 v12, v10, 4, v12
    v_add_u32 v12, s63, v12
    s_cmp_lt_u32 s52, 28
    s_cselect_b32 s56, -1, 0
    v_and_b32 v12, s56, v12
    v_cmp_eq_u32 vcc, 0, v9
    v_mov_b32 v13, s18
    v_mov_b32 v14, s16
    v_cndmask_b32 v13, v13, v14, vcc
    v_mov_b32 v14, s19
    v_mov_b32 v8, s17
    v_cndmask_b32 v14, v14, v8, vcc
    v_add_co_u32 v216, vcc, v13, v12
    s_nop 1
    v_addc_co_u32 v217, vcc, 0, v14, vcc
    v_add_co_u32 v218, vcc, 14336, v216
    s_nop 1
    v_addc_co_u32 v219, vcc, 0, v217, vcc
    v_add_co_u32 v220, vcc, 14336, v218
    s_nop 1
    v_addc_co_u32 v221, vcc, 0, v219, vcc
    v_add_co_u32 v222, vcc, 14336, v220
    s_nop 1
    v_addc_co_u32 v223, vcc, 0, v221, vcc
    s_cmp_eq_u32 s60, 0
    s_cselect_b64 s[22:23], -1, 0
    v_lshl_add_u32 v233, v3, 2, v2
    v_add_u32 v233, s49, v233
    v_lshlrev_b32 v234, 2, v233
    v_and_b32 v234, 0xff, v234
    v_lshlrev_b32 v233, 1, v233
    v_lshl_add_u32 v235, v2, 2, v3
    v_add_u32 v235, s49, v235
    v_lshlrev_b32 v235, 2, v235
    v_and_b32 v13, 12, v0
    v_cmp_eq_u32 vcc, 0, v13
    v_mov_b32 v13, 2147483632
    s_nop 0
    v_cndmask_b32 v235, v13, v235, vcc
    v_lshlrev_b32 v236, 4, v0
    s_lshl_b32 s56, s30, 10
    v_lshl_add_u32 v237, v0, 4, s56
    s_mov_b32 s57, 1035512379
    s_waitcnt vmcnt(7)
    s_waitcnt vmcnt(5)
    s_xor_b32 s54, s98, 1048576
    buffer_load_dwordx4 v[48:51], v1, s[36:39], s54 offen nt
    s_waitcnt vmcnt(5)
    s_xor_b32 s54, s98, 1052672
    buffer_load_dwordx4 v[52:55], v1, s[36:39], s54 offen nt
    s_waitcnt lgkmcnt(0)
    s_add_u32 s31, s31, 0x9E3779B1
    s_lshr_b32 s96, s31, 8
    s_or_b32 s96, s96, 1
    s_xor_b32 s96, s96, s31
    s_lshr_b32 s97, s31, 16
    s_getreg_b32 s56, hwreg(HW_REG_XCC_ID, 0, 4)
    s_and_b32 s63, s97, 0xf0
    s_or_b32 s63, s63, s56
    s_mov_b32 s58, 65536
    v_lshlrev_b32 v8, 3, v2
    v_lshrrev_b32 v8, v8, s31
    v_and_b32 v8, 0xff, v8
    v_cmp_eq_u32 vcc, 0, v3
    s_nop 1
    v_cndmask_b32 v8, 0, v8, vcc
    v_lshlrev_b32 v245, 3, v3
    v_lshrrev_b32 v245, v245, s31
    v_and_b32 v245, 0xff, v245
    s_waitcnt vmcnt(5)
    s_xor_b32 s54, s98, 1056768
    buffer_load_dwordx4 v[56:59], v1, s[36:39], s54 offen nt
    s_waitcnt vmcnt(5)
    s_xor_b32 s54, s98, 1060864
    buffer_load_dwordx4 v[60:63], v1, s[36:39], s54 offen nt
    s_waitcnt vmcnt(5)
    s_xor_b32 s54, s98, 1064960
    buffer_load_dwordx4 v[64:67], v1, s[36:39], s54 offen nt
    s_waitcnt vmcnt(5)
    s_xor_b32 s54, s98, 1069056
    buffer_load_dwordx4 v[68:71], v1, s[36:39], s54 offen nt
    s_waitcnt vmcnt(5)
    s_xor_b32 s54, s98, 1073152
    buffer_load_dwordx4 v[72:75], v1, s[36:39], s54 offen nt
    s_waitcnt vmcnt(5)
    s_xor_b32 s54, s98, 1077248
    buffer_load_dwordx4 v[76:79], v1, s[36:39], s54 offen nt
    s_waitcnt vmcnt(5)
    s_xor_b32 s54, s99, 0
    buffer_load_dwordx4 v[80:83], v228, s[44:47], s54 offen offset:0 nt
    s_waitcnt vmcnt(5)
    buffer_load_dwordx4 v[148:151], v4, s[32:35], s61 offen sc1
    s_waitcnt vmcnt(5)
    buffer_load_dwordx4 v[152:155], v4, s[32:35], s62 offen sc1
    s_waitcnt vmcnt(5)
    s_xor_b32 s54, s99, 4096
    buffer_load_dwordx4 v[84:87], v228, s[44:47], s54 offen offset:0 nt
    s_waitcnt vmcnt(5)
    s_xor_b32 s54, s99, 8192
    buffer_load_dwordx4 v[88:91], v228, s[44:47], s54 offen offset:0 nt
    s_waitcnt vmcnt(5)
    s_xor_b32 s54, s99, 12288
    buffer_load_dwordx4 v[92:95], v228, s[44:47], s54 offen offset:0 nt
    s_waitcnt vmcnt(5)
    s_xor_b32 s54, s99, 16384
    buffer_load_dwordx4 v[96:99], v228, s[44:47], s54 offen offset:0 nt
    s_waitcnt vmcnt(5)
    s_xor_b32 s54, s99, 20480
    buffer_load_dwordx4 v[100:103], v228, s[44:47], s54 offen offset:0 nt
    s_waitcnt vmcnt(5)
L_qpoll:
    v_bitop3_b32 v12, v148, v149, s31 bitop3:0x7e
    v_bitop3_b32 v13, v152, v153, s31 bitop3:0x7e
    v_bitop3_b32 v14, v150, v154, s96 bitop3:0x7e
    v_bitop3_b32 v15, v151, v155, s63 bitop3:0x7e
    v_or3_b32 v12, v12, v13, v14
    v_and_b32 v13, 0xf0, v15
    v_or_b32 v12, v12, v13
    v_cmp_ne_u32_sdwa vcc, v12, v246 src0_sel:BYTE_0 src1_sel:DWORD
    s_cbranch_vccnz L_qretry
L_qdone:
    v_and_b32 v15, 15, v15
    v_cmp_ne_u32 vcc, 0, v15
    s_xor_b32 s54, s99, 24576
    buffer_load_dwordx4 v[104:107], v228, s[44:47], s54 offen offset:0 nt
    v_and_b32 v148, 0xffffff00, v148
    v_and_b32 v149, 0xffffff00, v149
    v_and_b32 v150, 0xffffff00, v150
    v_and_b32 v151, 0xffffff00, v151
    v_and_b32 v152, 0xffffff00, v152
    v_and_b32 v153, 0xffffff00, v153
    v_and_b32 v154, 0xffffff00, v154
    v_and_b32 v155, 0xffffff00, v155
    s_cmp_eq_u64 vcc, 0
    s_cselect_b32 s56, 0, 1
    v_add_f32 v148, v148, v152
    v_add_f32 v149, v149, v153
    v_add_f32 v150, v150, v154
    v_add_f32 v151, v151, v155
    v_mov_b32 v12, s56
    v_permlane32_swap_b32 v148, v150
    v_permlane32_swap_b32 v149, v151
    ds_write_b32 v243, v12 offset:11264
    v_add_f32 v148, v148, v150
    v_add_f32 v149, v149, v151
    v_cvt_pk_bf16_f32 v148, v148, v149
    ds_write_b32 v6, v148 offset:3072
    s_waitcnt lgkmcnt(0)
    s_barrier
    ds_read_b128 v[148:151], v1 offset:3072
    ds_read_b128 v[152:155], v7 offset:3072
    ds_read_b128 v[12:15], v246 offset:11264
    ds_read_u16 v233, v233 offset:2048
    s_xor_b32 s54, s99, 28672
    buffer_load_dwordx4 v[108:111], v228, s[44:47], s54 offen offset:0 nt
    s_waitcnt lgkmcnt(0)
    v_mfma_f32_16x16x32_bf16 v[16:19], v[16:19], v[148:151], 0
    v_mfma_f32_16x16x32_bf16 v[24:27], v[24:27], v[148:151], 0
    v_mfma_f32_16x16x32_bf16 v[32:35], v[32:35], v[148:151], 0
    v_mfma_f32_16x16x32_bf16 v[40:43], v[40:43], v[148:151], 0
    v_mfma_f32_16x16x32_bf16 v[48:51], v[48:51], v[148:151], 0
    v_mfma_f32_16x16x32_bf16 v[56:59], v[56:59], v[148:151], 0
    v_mfma_f32_16x16x32_bf16 v[64:67], v[64:67], v[148:151], 0
    v_mfma_f32_16x16x32_bf16 v[72:75], v[72:75], v[148:151], 0
    v_mfma_f32_16x16x32_bf16 v[20:23], v[20:23], v[152:155], 0
    v_mfma_f32_16x16x32_bf16 v[28:31], v[28:31], v[152:155], 0
    v_mfma_f32_16x16x32_bf16 v[36:39], v[36:39], v[152:155], 0
    v_mfma_f32_16x16x32_bf16 v[44:47], v[44:47], v[152:155], 0
    v_mfma_f32_16x16x32_bf16 v[52:55], v[52:55], v[152:155], 0
    v_mfma_f32_16x16x32_bf16 v[60:63], v[60:63], v[152:155], 0
    v_mfma_f32_16x16x32_bf16 v[68:71], v[68:71], v[152:155], 0
    v_mfma_f32_16x16x32_bf16 v[76:79], v[76:79], v[152:155], 0
    v_or3_b32 v12, v12, v13, v14
    v_or_b32 v12, v12, v15
    s_nop 0
    v_readfirstlane_b32 s59, v12
    v_lshlrev_b32 v233, 16, v233
    s_mov_b32 exec_lo, 4042264335
    s_mov_b32 exec_hi, 4042264335
    v_mov_b32_dpp v156, v16 quad_perm:[0,0,0,0] row_mask:0xf bank_mask:0xf
    v_mov_b32_dpp v157, v24 quad_perm:[0,0,0,0] row_mask:0xf bank_mask:0xf
    v_mov_b32_dpp v158, v32 quad_perm:[0,0,0,0] row_mask:0xf bank_mask:0xf
    v_mov_b32_dpp v159, v40 quad_perm:[0,0,0,0] row_mask:0xf bank_mask:0xf
    v_mov_b32_dpp v160, v48 quad_perm:[0,0,0,0] row_mask:0xf bank_mask:0xf
    v_mov_b32_dpp v161, v56 quad_perm:[0,0,0,0] row_mask:0xf bank_mask:0xf
    v_mov_b32_dpp v162, v64 quad_perm:[0,0,0,0] row_mask:0xf bank_mask:0xf
    v_mov_b32_dpp v163, v72 quad_perm:[0,0,0,0] row_mask:0xf bank_mask:0xf
    v_add_f32_dpp v156, v17, v156 quad_perm:[1,1,1,1] row_mask:0xf bank_mask:0xf
    v_add_f32_dpp v157, v25, v157 quad_perm:[1,1,1,1] row_mask:0xf bank_mask:0xf
    v_add_f32_dpp v158, v33, v158 quad_perm:[1,1,1,1] row_mask:0xf bank_mask:0xf
    v_add_f32_dpp v159, v41, v159 quad_perm:[1,1,1,1] row_mask:0xf bank_mask:0xf
    v_add_f32_dpp v160, v49, v160 quad_perm:[1,1,1,1] row_mask:0xf bank_mask:0xf
    v_add_f32_dpp v161, v57, v161 quad_perm:[1,1,1,1] row_mask:0xf bank_mask:0xf
    v_add_f32_dpp v162, v65, v162 quad_perm:[1,1,1,1] row_mask:0xf bank_mask:0xf
    v_add_f32_dpp v163, v73, v163 quad_perm:[1,1,1,1] row_mask:0xf bank_mask:0xf
    v_add_f32_dpp v156, v18, v156 quad_perm:[2,2,2,2] row_mask:0xf bank_mask:0xf
    v_add_f32_dpp v157, v26, v157 quad_perm:[2,2,2,2] row_mask:0xf bank_mask:0xf
    v_add_f32_dpp v158, v34, v158 quad_perm:[2,2,2,2] row_mask:0xf bank_mask:0xf
    v_add_f32_dpp v159, v42, v159 quad_perm:[2,2,2,2] row_mask:0xf bank_mask:0xf
    v_add_f32_dpp v160, v50, v160 quad_perm:[2,2,2,2] row_mask:0xf bank_mask:0xf
    v_add_f32_dpp v161, v58, v161 quad_perm:[2,2,2,2] row_mask:0xf bank_mask:0xf
    v_add_f32_dpp v162, v66, v162 quad_perm:[2,2,2,2] row_mask:0xf bank_mask:0xf
    v_add_f32_dpp v163, v74, v163 quad_perm:[2,2,2,2] row_mask:0xf bank_mask:0xf
    v_add_f32_dpp v156, v19, v156 quad_perm:[3,3,3,3] row_mask:0xf bank_mask:0xf
    v_add_f32_dpp v157, v27, v157 quad_perm:[3,3,3,3] row_mask:0xf bank_mask:0xf
    v_add_f32_dpp v158, v35, v158 quad_perm:[3,3,3,3] row_mask:0xf bank_mask:0xf
    v_add_f32_dpp v159, v43, v159 quad_perm:[3,3,3,3] row_mask:0xf bank_mask:0xf
    v_add_f32_dpp v160, v51, v160 quad_perm:[3,3,3,3] row_mask:0xf bank_mask:0xf
    v_add_f32_dpp v161, v59, v161 quad_perm:[3,3,3,3] row_mask:0xf bank_mask:0xf
    v_add_f32_dpp v162, v67, v162 quad_perm:[3,3,3,3] row_mask:0xf bank_mask:0xf
    v_add_f32_dpp v163, v75, v163 quad_perm:[3,3,3,3] row_mask:0xf bank_mask:0xf
    s_mov_b64 exec, -1
    s_xor_b32 s54, s99, 1048576
    buffer_load_dwordx4 v[112:115], v228, s[44:47], s54 offen offset:0 nt
    s_mov_b32 exec_lo, 252702960
    s_mov_b32 exec_hi, 252702960
    v_mov_b32_dpp v156, v20 quad_perm:[0,0,0,0] row_mask:0xf bank_mask:0xf
    v_mov_b32_dpp v157, v28 quad_perm:[0,0,0,0] row_mask:0xf bank_mask:0xf
    v_mov_b32_dpp v158, v36 quad_perm:[0,0,0,0] row_mask:0xf bank_mask:0xf
    v_mov_b32_dpp v159, v44 quad_perm:[0,0,0,0] row_mask:0xf bank_mask:0xf
    v_mov_b32_dpp v160, v52 quad_perm:[0,0,0,0] row_mask:0xf bank_mask:0xf
    v_mov_b32_dpp v161, v60 quad_perm:[0,0,0,0] row_mask:0xf bank_mask:0xf
    v_mov_b32_dpp v162, v68 quad_perm:[0,0,0,0] row_mask:0xf bank_mask:0xf
    v_mov_b32_dpp v163, v76 quad_perm:[0,0,0,0] row_mask:0xf bank_mask:0xf
    v_add_f32_dpp v156, v21, v156 quad_perm:[1,1,1,1] row_mask:0xf bank_mask:0xf
    v_add_f32_dpp v157, v29, v157 quad_perm:[1,1,1,1] row_mask:0xf bank_mask:0xf
    v_add_f32_dpp v158, v37, v158 quad_perm:[1,1,1,1] row_mask:0xf bank_mask:0xf
    v_add_f32_dpp v159, v45, v159 quad_perm:[1,1,1,1] row_mask:0xf bank_mask:0xf
    v_add_f32_dpp v160, v53, v160 quad_perm:[1,1,1,1] row_mask:0xf bank_mask:0xf
    v_add_f32_dpp v161, v61, v161 quad_perm:[1,1,1,1] row_mask:0xf bank_mask:0xf
    v_add_f32_dpp v162, v69, v162 quad_perm:[1,1,1,1] row_mask:0xf bank_mask:0xf
    v_add_f32_dpp v163, v77, v163 quad_perm:[1,1,1,1] row_mask:0xf bank_mask:0xf
    v_add_f32_dpp v156, v22, v156 quad_perm:[2,2,2,2] row_mask:0xf bank_mask:0xf
    v_add_f32_dpp v157, v30, v157 quad_perm:[2,2,2,2] row_mask:0xf bank_mask:0xf
    v_add_f32_dpp v158, v38, v158 quad_perm:[2,2,2,2] row_mask:0xf bank_mask:0xf
    v_add_f32_dpp v159, v46, v159 quad_perm:[2,2,2,2] row_mask:0xf bank_mask:0xf
    v_add_f32_dpp v160, v54, v160 quad_perm:[2,2,2,2] row_mask:0xf bank_mask:0xf
    v_add_f32_dpp v161, v62, v161 quad_perm:[2,2,2,2] row_mask:0xf bank_mask:0xf
    v_add_f32_dpp v162, v70, v162 quad_perm:[2,2,2,2] row_mask:0xf bank_mask:0xf
    v_add_f32_dpp v163, v78, v163 quad_perm:[2,2,2,2] row_mask:0xf bank_mask:0xf
    v_add_f32_dpp v156, v23, v156 quad_perm:[3,3,3,3] row_mask:0xf bank_mask:0xf
    v_add_f32_dpp v157, v31, v157 quad_perm:[3,3,3,3] row_mask:0xf bank_mask:0xf
    v_add_f32_dpp v158, v39, v158 quad_perm:[3,3,3,3] row_mask:0xf bank_mask:0xf
    v_add_f32_dpp v159, v47, v159 quad_perm:[3,3,3,3] row_mask:0xf bank_mask:0xf
    v_add_f32_dpp v160, v55, v160 quad_perm:[3,3,3,3] row_mask:0xf bank_mask:0xf
    v_add_f32_dpp v161, v63, v161 quad_perm:[3,3,3,3] row_mask:0xf bank_mask:0xf
    v_add_f32_dpp v162, v71, v162 quad_perm:[3,3,3,3] row_mask:0xf bank_mask:0xf
    v_add_f32_dpp v163, v79, v163 quad_perm:[3,3,3,3] row_mask:0xf bank_mask:0xf
    s_mov_b64 exec, -1
    v_permlane16_swap_b32 v156, v157
    v_permlane16_swap_b32 v158, v159
    v_permlane16_swap_b32 v160, v161
    v_permlane16_swap_b32 v162, v163
    v_add_f32_dpp v16, v157, v156 row_half_mirror row_mask:0xf bank_mask:0xf
    v_add_f32_dpp v17, v159, v158 row_half_mirror row_mask:0xf bank_mask:0xf
    v_add_f32_dpp v18, v161, v160 row_half_mirror row_mask:0xf bank_mask:0xf
    v_add_f32_dpp v19, v163, v162 row_half_mirror row_mask:0xf bank_mask:0xf
    v_cvt_pk_bf16_f32 v17, v16, v17
    v_cvt_pk_bf16_f32 v19, v18, v19
    v_lshlrev_b32 v16, 16, v17
    v_and_b32 v17, 0xffff0000, v17
    v_lshlrev_b32 v18, 16, v19
    v_and_b32 v19, 0xffff0000, v19
    v_max3_f32 v4, v16, v17, v18
    v_max_f32 v4, v4, v19
    s_nop 1
    v_max_f32_dpp v4, v4, v4 row_half_mirror row_mask:0xf bank_mask:0xf
    v_mov_b32 v5, v4
    s_nop 1
    v_permlane16_swap_b32 v4, v5
    v_max_f32 v4, v4, v5
    v_mov_b32 v5, v4
    s_nop 1
    v_permlane32_swap_b32 v4, v5
    v_max_f32 v4, v4, v5
    s_xor_b32 s54, s99, 1052672
    buffer_load_dwordx4 v[116:119], v228, s[44:47], s54 offen offset:0 nt
    v_sub_f32 v16, v16, v4
    v_sub_f32 v17, v17, v4
    v_sub_f32 v18, v18, v4
    v_sub_f32 v19, v19, v4
    v_mul_f32 v16, s57, v16
    v_mul_f32 v17, s57, v17
    v_mul_f32 v18, s57, v18
    v_mul_f32 v19, s57, v19
    v_exp_f32 v16, v16
    v_exp_f32 v17, v17
    v_exp_f32 v18, v18
    v_exp_f32 v19, v19
    v_add_f32 v5, v16, v17
    v_add_f32 v5, v5, v18
    v_add_f32 v5, v5, v19
    s_nop 1
    v_add_f32_dpp v5, v5, v5 row_half_mirror row_mask:0xf bank_mask:0xf
    v_mov_b32 v6, v5
    s_nop 1
    v_permlane16_swap_b32 v5, v6
    v_add_f32 v5, v5, v6
    v_mov_b32 v6, v5
    s_nop 1
    v_permlane32_swap_b32 v5, v6
    v_add_f32 v5, v5, v6
    s_mov_b32 exec_lo, 0x11111111
    s_mov_b32 exec_hi, 0x11111111
    ds_write_b128 v239, v[16:19] offset:4096
    ds_write_b32 v240, v4 offset:11520
    ds_write_b32 v240, v5 offset:11552
    s_mov_b64 exec, -1
    s_waitcnt lgkmcnt(0)
    s_barrier
    ds_read_b128 v[12:15], v242 offset:11520
    ds_read_b128 v[32:35], v241 offset:4096
    ds_read_b128 v[36:39], v241 offset:4352
    ds_read_b128 v[40:43], v241 offset:4608
    ds_read_b128 v[44:47], v241 offset:4864
    ds_read_b32 v48, v241 offset:5004
    s_xor_b32 s54, s99, 1056768
    buffer_load_dwordx4 v[120:123], v228, s[44:47], s54 offen offset:0 nt
    s_waitcnt lgkmcnt(5)
    v_max3_f32 v4, v12, v13, v14
    v_max_f32 v4, v4, v15
    v_cmp_gt_u32 vcc, 32, v0
    s_nop 1
    v_cndmask_b32 v12, v13, v12, vcc
    v_cndmask_b32 v13, v15, v14, vcc
    v_cndmask_b32 v12, v13, v12, s[22:23]
    v_sub_f32 v12, v12, v4
    v_sub_f32 v13, v13, v4
    v_mul_f32 v12, s57, v12
    v_mul_f32 v13, s57, v13
    v_exp_f32 v12, v12
    v_exp_f32 v13, v13
    s_waitcnt lgkmcnt(0)
    v_pk_mul_f32 v[32:33], v[32:33], v[12:13] op_sel:[0,0] op_sel_hi:[1,0]
    v_pk_mul_f32 v[34:35], v[34:35], v[12:13] op_sel:[0,0] op_sel_hi:[1,0]
    v_pk_mul_f32 v[36:37], v[36:37], v[12:13] op_sel:[0,0] op_sel_hi:[1,0]
    v_pk_mul_f32 v[38:39], v[38:39], v[12:13] op_sel:[0,0] op_sel_hi:[1,0]
    v_pk_mul_f32 v[40:41], v[40:41], v[12:13] op_sel:[0,0] op_sel_hi:[1,0]
    v_pk_mul_f32 v[42:43], v[42:43], v[12:13] op_sel:[0,0] op_sel_hi:[1,0]
    v_pk_mul_f32 v[44:45], v[44:45], v[12:13] op_sel:[0,0] op_sel_hi:[1,0]
    v_pk_mul_f32 v[46:47], v[46:47], v[12:13] op_sel:[0,0] op_sel_hi:[1,0]
    v_mul_f32 v48, v48, v13
    v_cvt_pk_bf16_f32 v32, v32, v32
    v_cvt_pk_bf16_f32 v33, v33, v33
    v_cvt_pk_bf16_f32 v34, v34, v34
    v_cvt_pk_bf16_f32 v35, v35, v35
    v_cvt_pk_bf16_f32 v36, v36, v36
    v_cvt_pk_bf16_f32 v37, v37, v37
    v_cvt_pk_bf16_f32 v38, v38, v38
    v_cvt_pk_bf16_f32 v39, v39, v39
    v_cvt_pk_bf16_f32 v40, v40, v40
    v_cvt_pk_bf16_f32 v41, v41, v41
    v_cvt_pk_bf16_f32 v42, v42, v42
    v_cvt_pk_bf16_f32 v43, v43, v43
    v_cvt_pk_bf16_f32 v44, v44, v44
    v_cvt_pk_bf16_f32 v45, v45, v45
    v_cvt_pk_bf16_f32 v46, v46, v46
    v_cvt_pk_bf16_f32 v47, v47, v47
    v_cvt_pk_bf16_f32 v48, v48, v48
    v_and_b32 v200, v32, v164
    v_and_b32 v201, v32, v165
    v_and_b32 v202, v32, v166
    v_and_b32 v203, v32, v167
    s_waitcnt vmcnt(5)
    s_xor_b32 s54, s99, 1060864
    buffer_load_dwordx4 v[124:127], v228, s[44:47], s54 offen offset:0 nt
    v_and_b32 v204, v36, v164
    v_and_b32 v205, v36, v165
    v_and_b32 v206, v36, v166
    v_and_b32 v207, v36, v167
    v_mfma_f32_16x16x32_bf16 v[12:15], v[200:203], v[80:83], 0
    v_and_b32 v208, v40, v164
    v_and_b32 v209, v40, v165
    v_and_b32 v210, v40, v166
    v_and_b32 v211, v40, v167
    v_mfma_f32_16x16x32_bf16 v[12:15], v[204:207], v[84:87], v[12:15]
    v_and_b32 v212, v44, v164
    v_and_b32 v213, v44, v165
    v_and_b32 v214, v44, v166
    v_and_b32 v215, v44, v167
    v_mfma_f32_16x16x32_bf16 v[12:15], v[208:211], v[88:91], v[12:15]
    v_and_b32 v200, v33, v164
    v_and_b32 v201, v33, v165
    v_and_b32 v202, v33, v166
    v_and_b32 v203, v33, v167
    v_mfma_f32_16x16x32_bf16 v[12:15], v[212:215], v[92:95], v[12:15]
    s_branch L_K2
.p2align 12
L_Q1:
    s_mov_b64 s[32:33], s[26:27]
    s_mov_b32 s34, 2097152
    s_mov_b32 s35, 0x00020000
    s_mov_b64 s[40:41], s[22:23]
    s_mov_b32 s42, 896
    s_mov_b32 s43, 0x00020000
    s_mov_b64 s[44:45], s[20:21]
    s_mov_b32 s46, 1605632
    s_mov_b32 s47, 0x00020000
    s_mul_i32 s50, s29, 37
    s_lshr_b32 s50, s50, 8
    s_mul_i32 s51, s50, 7
    s_sub_u32 s51, s29, s51
    s_lshl_b32 s101, s28, 2
    s_lshr_b32 s101, 839939668, s101
    s_and_b32 s101, s101, 7
    s_lshl_b32 s52, s50, 3
    s_add_u32 s52, s52, s101
    s_mul_i32 s100, s101, 3
    s_min_u32 s101, s101, 4
    s_add_u32 s100, s100, s101
    s_add_u32 s100, s100, s50
    s_min_u32 s100, s100, 27
    v_and_b32 v72, 1, v0
    v_lshlrev_b32 v72, 4, v72
    v_mov_b32 v73, 0xffff
    v_lshlrev_b32 v73, v72, v73
    v_bfe_u32 v72, v0, 1, 2
    v_cmp_eq_u32 vcc, 0, v72
    s_nop 1
    v_cndmask_b32 v112, 0, v73, vcc
    v_cmp_eq_u32 vcc, 1, v72
    s_nop 1
    v_cndmask_b32 v113, 0, v73, vcc
    v_cmp_eq_u32 vcc, 2, v72
    s_nop 1
    v_cndmask_b32 v114, 0, v73, vcc
    v_cmp_eq_u32 vcc, 3, v72
    s_nop 1
    v_cndmask_b32 v115, 0, v73, vcc
    v_mov_b32 v246, 0
    v_mov_b32 v245, 0xff
    s_waitcnt vmcnt(14)
    ds_write_b128 v1, v[8:11] offset:2048
    v_lshlrev_b32 v80, 16, v8
    v_and_b32 v81, 0xffff0000, v8
    v_lshlrev_b32 v82, 16, v9
    v_and_b32 v83, 0xffff0000, v9
    v_lshlrev_b32 v84, 16, v10
    v_and_b32 v85, 0xffff0000, v10
    v_lshlrev_b32 v86, 16, v11
    v_and_b32 v87, 0xffff0000, v11
    v_add_f32 v72, v80, v81
    v_add_f32 v72, v72, v82
    v_add_f32 v72, v72, v83
    v_add_f32 v72, v72, v84
    v_add_f32 v72, v72, v85
    v_add_f32 v72, v72, v86
    v_add_f32 v72, v72, v87
    s_nop 1
    v_add_f32_dpp v72, v72, v72 row_ror:8 row_mask:0xf bank_mask:0xf
    s_nop 1
    v_add_f32_dpp v72, v72, v72 row_ror:4 row_mask:0xf bank_mask:0xf
    s_nop 1
    v_add_f32_dpp v72, v72, v72 row_ror:2 row_mask:0xf bank_mask:0xf
    s_nop 1
    v_add_f32_dpp v72, v72, v72 row_ror:1 row_mask:0xf bank_mask:0xf
    v_mov_b32 v73, v72
    s_nop 1
    v_permlane16_swap_b32 v72, v73
    v_add_f32 v72, v72, v73
    v_mov_b32 v73, v72
    s_nop 1
    v_permlane32_swap_b32 v72, v73
    v_add_f32 v72, v72, v73
    v_mul_f32 v72, 991054117, v72
    v_mov_b32 v73, 0
    v_sub_f32 v74, v80, v72
    v_fmac_f32 v73, v74, v74
    v_sub_f32 v74, v81, v72
    v_fmac_f32 v73, v74, v74
    v_sub_f32 v74, v82, v72
    v_fmac_f32 v73, v74, v74
    v_sub_f32 v74, v83, v72
    v_fmac_f32 v73, v74, v74
    v_sub_f32 v74, v84, v72
    v_fmac_f32 v73, v74, v74
    v_sub_f32 v74, v85, v72
    v_fmac_f32 v73, v74, v74
    v_sub_f32 v74, v86, v72
    v_fmac_f32 v73, v74, v74
    v_sub_f32 v74, v87, v72
    v_fmac_f32 v73, v74, v74
    v_cmp_gt_u32 vcc, 56, v0
    s_nop 1
    v_cndmask_b32 v73, 0, v73, vcc
    s_nop 1
    v_add_f32_dpp v73, v73, v73 row_ror:8 row_mask:0xf bank_mask:0xf
    s_nop 1
    v_add_f32_dpp v73, v73, v73 row_ror:4 row_mask:0xf bank_mask:0xf
    s_nop 1
    v_add_f32_dpp v73, v73, v73 row_ror:2 row_mask:0xf bank_mask:0xf
    s_nop 1
    v_add_f32_dpp v73, v73, v73 row_ror:1 row_mask:0xf bank_mask:0xf
    v_mov_b32 v74, v73
    s_nop 1
    v_permlane16_swap_b32 v73, v74
    v_add_f32 v73, v73, v74
    v_mov_b32 v74, v73
    s_nop 1
    v_permlane32_swap_b32 v73, v74
    v_add_f32 v73, v73, v74
    v_mul_f32 v73, 991054117, v73
    v_cvt_pk_bf16_f32 v72, v72, v72
    v_and_b32 v72, 0xffff0000, v72
    v_cvt_pk_bf16_f32 v73, v73, v73
    v_and_b32 v73, 0xffff0000, v73
    v_add_f32 v73, 925353388, v73
    v_cvt_pk_bf16_f32 v73, v73, v73
    v_and_b32 v73, 0xffff0000, v73
    v_sqrt_f32 v73, v73
    s_nop 0
    v_cvt_pk_bf16_f32 v73, v73, v73
    v_and_b32 v73, 0xffff0000, v73
    v_rcp_f32 v74, v73
    v_sub_f32 v80, v80, v72
    v_sub_f32 v81, v81, v72
    v_sub_f32 v82, v82, v72
    v_sub_f32 v83, v83, v72
    v_sub_f32 v84, v84, v72
    v_sub_f32 v85, v85, v72
    v_sub_f32 v86, v86, v72
    v_sub_f32 v87, v87, v72
    v_cvt_pk_bf16_f32 v81, v80, v81
    v_cvt_pk_bf16_f32 v83, v82, v83
    v_cvt_pk_bf16_f32 v85, v84, v85
    v_cvt_pk_bf16_f32 v87, v86, v87
    v_lshlrev_b32 v80, 16, v81
    v_and_b32 v81, 0xffff0000, v81
    v_lshlrev_b32 v82, 16, v83
    v_and_b32 v83, 0xffff0000, v83
    v_lshlrev_b32 v84, 16, v85
    v_and_b32 v85, 0xffff0000, v85
    v_lshlrev_b32 v86, 16, v87
    v_and_b32 v87, 0xffff0000, v87
    v_mul_f32 v88, v80, v74
    v_mul_f32 v89, v81, v74
    v_mul_f32 v90, v82, v74
    v_mul_f32 v91, v83, v74
    v_mul_f32 v92, v84, v74
    v_mul_f32 v93, v85, v74
    v_mul_f32 v94, v86, v74
    v_mul_f32 v95, v87, v74
    v_fma_f32 v80, -v88, v73, v80
    v_fma_f32 v81, -v89, v73, v81
    v_fma_f32 v82, -v90, v73, v82
    v_fma_f32 v83, -v91, v73, v83
    v_fma_f32 v84, -v92, v73, v84
    v_fma_f32 v85, -v93, v73, v85
    v_fma_f32 v86, -v94, v73, v86
    v_fma_f32 v87, -v95, v73, v87
    v_fmac_f32 v88, v80, v74
    v_fmac_f32 v89, v81, v74
    v_fmac_f32 v90, v82, v74
    v_fmac_f32 v91, v83, v74
    v_fmac_f32 v92, v84, v74
    v_fmac_f32 v93, v85, v74
    v_fmac_f32 v94, v86, v74
    v_fmac_f32 v95, v87, v74
    v_cvt_pk_bf16_f32 v80, v88, v88
    v_cvt_pk_bf16_f32 v81, v89, v89
    v_cvt_pk_bf16_f32 v82, v90, v90
    v_cvt_pk_bf16_f32 v83, v91, v91
    v_cvt_pk_bf16_f32 v84, v92, v92
    v_cvt_pk_bf16_f32 v85, v93, v93
    v_cvt_pk_bf16_f32 v86, v94, v94
    v_cvt_pk_bf16_f32 v87, v95, v95
    v_lshlrev_b32 v72, 5, v0
    ds_write_b128 v72, v[80:83] offset:0
    ds_write_b128 v72, v[84:87] offset:16
    v_mul_u32_u24 v73, 56, v2
    s_mul_i32 s56, s48, 448
    v_add_u32 v73, s56, v73
    s_waitcnt lgkmcnt(0)
    ds_read_b64 v[96:97], v73 offset:0
    ds_read_b64 v[98:99], v73 offset:8
    ds_read_b64 v[100:101], v73 offset:16
    ds_read_b64 v[102:103], v73 offset:24
    ds_read_b64 v[104:105], v73 offset:32
    ds_read_b64 v[106:107], v73 offset:40
    ds_read_b64 v[108:109], v73 offset:48
    s_add_u32 s31, s31, 0x9E3779B1
    s_lshr_b32 s96, s31, 8
    s_or_b32 s96, s96, 1
    s_xor_b32 s96, s96, s31
    s_lshr_b32 s97, s31, 16
    s_getreg_b32 s56, hwreg(HW_REG_XCC_ID, 0, 4)
    s_and_b32 s63, s97, 0xf0
    s_or_b32 s63, s63, s56
    s_waitcnt lgkmcnt(0)
    v_and_b32 v116, v96, v112
    v_and_b32 v117, v96, v113
    v_and_b32 v118, v96, v114
    v_and_b32 v119, v96, v115
    v_and_b32 v120, v97, v112
    v_and_b32 v121, v97, v113
    v_and_b32 v122, v97, v114
    v_and_b32 v123, v97, v115
    s_waitcnt vmcnt(13)
    v_mfma_f32_16x16x32_bf16 v[8:11], v[116:119], v[16:19], 0
    v_and_b32 v116, v98, v112
    v_and_b32 v117, v98, v113
    v_and_b32 v118, v98, v114
    v_and_b32 v119, v98, v115
    s_waitcnt vmcnt(12)
    v_mfma_f32_16x16x32_bf16 v[8:11], v[120:123], v[20:23], v[8:11]
    v_and_b32 v120, v99, v112
    v_and_b32 v121, v99, v113
    v_and_b32 v122, v99, v114
    v_and_b32 v123, v99, v115
    s_waitcnt vmcnt(11)
    v_mfma_f32_16x16x32_bf16 v[8:11], v[116:119], v[24:27], v[8:11]
    v_and_b32 v116, v100, v112
    v_and_b32 v117, v100, v113
    v_and_b32 v118, v100, v114
    v_and_b32 v119, v100, v115
    s_waitcnt vmcnt(10)
    v_mfma_f32_16x16x32_bf16 v[8:11], v[120:123], v[28:31], v[8:11]
    v_and_b32 v120, v101, v112
    v_and_b32 v121, v101, v113
    v_and_b32 v122, v101, v114
    v_and_b32 v123, v101, v115
    s_waitcnt vmcnt(9)
    v_mfma_f32_16x16x32_bf16 v[8:11], v[116:119], v[32:35], v[8:11]
    v_and_b32 v116, v102, v112
    v_and_b32 v117, v102, v113
    v_and_b32 v118, v102, v114
    v_and_b32 v119, v102, v115
    s_waitcnt vmcnt(8)
    v_mfma_f32_16x16x32_bf16 v[8:11], v[120:123], v[36:39], v[8:11]
    v_and_b32 v120, v103, v112
    v_and_b32 v121, v103, v113
    v_and_b32 v122, v103, v114
    v_and_b32 v123, v103, v115
    s_waitcnt vmcnt(7)
    v_mfma_f32_16x16x32_bf16 v[8:11], v[116:119], v[40:43], v[8:11]
    v_and_b32 v116, v104, v112
    v_and_b32 v117, v104, v113
    v_and_b32 v118, v104, v114
    v_and_b32 v119, v104, v115
    s_waitcnt vmcnt(6)
    v_mfma_f32_16x16x32_bf16 v[8:11], v[120:123], v[44:47], v[8:11]
    v_and_b32 v120, v105, v112
    v_and_b32 v121, v105, v113
    v_and_b32 v122, v105, v114
    v_and_b32 v123, v105, v115
    s_waitcnt vmcnt(5)
    v_mfma_f32_16x16x32_bf16 v[8:11], v[116:119], v[48:51], v[8:11]
    v_and_b32 v116, v106, v112
    v_and_b32 v117, v106, v113
    v_and_b32 v118, v106, v114
    v_and_b32 v119, v106, v115
    s_waitcnt vmcnt(4)
    v_mfma_f32_16x16x32_bf16 v[8:11], v[120:123], v[52:55], v[8:11]
    v_and_b32 v120, v107, v112
    v_and_b32 v121, v107, v113
    v_and_b32 v122, v107, v114
    v_and_b32 v123, v107, v115
    s_waitcnt vmcnt(3)
    v_mfma_f32_16x16x32_bf16 v[8:11], v[116:119], v[56:59], v[8:11]
    v_and_b32 v116, v108, v112
    v_and_b32 v117, v108, v113
    v_and_b32 v118, v108, v114
    v_and_b32 v119, v108, v115
    s_waitcnt vmcnt(2)
    v_mfma_f32_16x16x32_bf16 v[8:11], v[120:123], v[60:63], v[8:11]
    v_and_b32 v120, v109, v112
    v_and_b32 v121, v109, v113
    v_and_b32 v122, v109, v114
    v_and_b32 v123, v109, v115
    s_waitcnt vmcnt(1)
    v_mfma_f32_16x16x32_bf16 v[8:11], v[116:119], v[64:67], v[8:11]
    s_waitcnt vmcnt(0)
    v_mfma_f32_16x16x32_bf16 v[8:11], v[120:123], v[68:71], v[8:11]
    v_lshrrev_b32 v5, 4, v0
    v_lshlrev_b32 v72, 4, v5
    v_lshl_add_u32 v72, v3, 5, v72
    v_and_b32 v73, 40, v0
    v_mov_b32 v12, 2147483632
    v_cmp_eq_u32 vcc, 0, v73
    s_nop 1
    v_cndmask_b32 v72, v12, v72, vcc
    s_lshl_b32 s54, s28, 13
    s_add_u32 s54, s54, 65536
    s_lshl_b32 s56, s48, 11
    s_add_u32 s56, s56, s54
    s_lshl_b32 s61, s49, 8
    s_add_u32 s56, s56, s61
    v_mov_b32_dpp v80, v8 row_ror:8 row_mask:0xf bank_mask:0xf
    v_mov_b32_dpp v81, v9 row_ror:8 row_mask:0xf bank_mask:0xf
    v_mov_b32_dpp v82, v10 row_ror:8 row_mask:0xf bank_mask:0xf
    v_mov_b32_dpp v83, v11 row_ror:8 row_mask:0xf bank_mask:0xf
    v_permlane32_swap_b32 v80, v84
    v_permlane32_swap_b32 v81, v85
    v_permlane32_swap_b32 v82, v86
    v_permlane32_swap_b32 v83, v87
    v_add_f32 v8, v8, v84
    v_add_f32 v9, v9, v85
    v_add_f32 v10, v10, v86
    v_add_f32 v11, v11, v87
    v_add_u32 v8, 0x80, v8
    v_add_u32 v9, 0x80, v9
    v_add_u32 v10, 0x80, v10
    v_add_u32 v11, 0x80, v11
    v_bfi_b32 v8, v245, s31, v8
    v_bfi_b32 v9, v245, s31, v9
    v_bfi_b32 v10, v245, s96, v10
    v_bfi_b32 v11, v245, s63, v11
    buffer_store_dwordx4 v[8:11], v72, s[32:35], s56 offen
    s_mov_b32 s3, s56
    v_mov_b32 v71, v72
    s_mov_b64 exec, vcc
    ds_write_b128 v72, v[8:11] offset:12032
    s_mov_b64 exec, -1
    s_lshr_b32 s53, s2, 6
    s_lshl_b32 s53, s53, 14
    s_and_b32 s56, s2, 63
    s_lshl_b32 s56, s56, 7
    s_add_u32 s53, s53, s56
    s_add_u32 s53, s53, 1441792
    v_lshlrev_b32 v6, 10, v0
    v_and_b32 v6, 0x2000, v6
    v_lshl_add_u32 v6, v3, 4, v6
    v_mov_b32 v16, 0x100
    v_mov_b32 v17, 0x100
    v_mov_b32 v18, 0x100
    v_mov_b32 v19, 0x100
    s_cmp_lt_u32 s29, 28
    s_cbranch_scc1 L_noprobe
    s_mov_b64 exec, 0xffff
    buffer_store_dwordx4 v[16:19], v6, s[32:35], s53 offen sc1
    s_mov_b64 exec, -1
L_noprobe:
    s_setprio 0
    s_lshl_b32 s54, s55, 11
    s_add_u32 s54, s54, 262144
    v_lshl_add_u32 v6, v0, 7, s54
    s_lshr_b32 s48, s29, 3
    s_and_b32 s49, s29, 7
    s_lshl_b32 s60, s49, 6
    s_lshl_b32 s56, s48, 4
    s_add_u32 s60, s60, s56
    s_lshl_b32 s56, s28, 9
    s_add_u32 s60, s60, s56
    s_add_u32 s60, s60, 131072
    s_mul_i32 s61, s52, 7168
    s_add_u32 s61, s61, 851968
    s_lshl_b32 s56, s51, 10
    s_add_u32 s62, s61, s56
    s_sub_u32 s56, s62, 2048
    v_lshl_add_u32 v7, v0, 7, s56
    v_cmp_gt_u32 vcc, 16, v0
    s_nop 1
    v_cndmask_b32 v6, v7, v6, vcc
    s_lshl_b32 s63, s52, 11
    s_add_u32 s63, s63, 786432
    s_lshl_b32 s56, s51, 8
    s_add_u32 s56, s56, s63
    v_writelane_b32 v6, s56, 24
    s_add_u32 s56, s56, 128
    v_writelane_b32 v6, s56, 25
    v_writelane_b32 v6, s60, 26
    s_cmp_lt_u32 s52, 28
    s_cselect_b32 s56, 0x03ff0000, 0
    s_or_b32 exec_lo, s56, 67174399
    s_mov_b32 exec_hi, 0
    buffer_load_dword v13, v6, s[32:35], 0 offen sc1
    s_mov_b64 exec, -1
    v_cmp_eq_u32 vcc, 0, v0
    s_nop 1
    v_cndmask_b32 v14, v12, v0, vcc
    v_and_b32 v72, 1, v0
    v_lshlrev_b32 v72, 4, v72
    s_mov_b32 s57, 1035512379
    v_and_b32 v3, 3, v0
    v_and_b32 v6, 1, v5
    v_lshlrev_b32 v6, 2, v6
    v_lshrrev_b32 v7, 1, v5
    v_lshl_add_u32 v6, v7, 1, v6
    v_mul_u32_u24 v6, 896, v6
    v_and_b32 v7, 15, v0
    v_lshl_add_u32 v6, v7, 3, v6
    s_mul_i32 s48, s100, 57344
    s_lshl_b32 s56, s51, 7
    s_add_u32 s48, s48, s56
    s_mul_i32 s49, s51, 16384
    s_lshl_b32 s56, s28, 8
    s_add_u32 s49, s49, s56
    s_lshl_b32 s56, s50, 6
    s_add_u32 s49, s49, s56
    s_add_u32 s49, s49, 1179648
    v_lshlrev_b32 v253, 11, v0
    v_lshrrev_b32 v252, 4, v0
    v_lshlrev_b32 v252, 9, v252
    v_add_lshl_u32 v252, v252, v7, 2
    v_lshlrev_b32 v2, 2, v0
    v_lshlrev_b32 v244, 3, v3
    v_lshrrev_b32 v244, v244, s31
    v_and_b32 v244, 0xff, v244
    v_bfe_u32 v15, v0, 2, 2
    v_lshlrev_b32 v15, 3, v15
    v_lshrrev_b32 v15, v15, s31
    v_and_b32 v15, 0xff, v15
    v_cmp_eq_u32 vcc, 0, v3
    s_nop 1
    v_cndmask_b32 v243, 0, v245, vcc
    s_mul_i32 s54, s51, 16384
    s_add_u32 s54, s54, 1310720
    s_lshl_b32 s56, s52, 8
    s_add_u32 s54, s54, s56
    v_lshlrev_b32 v249, 7, v0
    v_lshlrev_b32 v250, 12, v0
    v_and_b32 v249, 0x80, v249
    v_and_b32 v250, 0x2000, v250
    v_or_b32 v249, v249, v250
    s_cmp_ge_u32 s29, 28
    s_cbranch_scc1 L_nopre
    s_mov_b64 exec, 0xff
    buffer_load_dword v250, v253, s[32:35], s49 offen sc1
    s_mov_b64 exec, 15
    s_cmp_ge_u32 s52, 28
    s_cbranch_scc1 L_nopre
    buffer_load_dword v250, v249, s[32:35], s54 offen sc1
    s_lshr_b32 s56, s52, 2
    s_cmp_lg_u32 s28, 6
    s_cbranch_scc1 L_nopre
L_opre:
    s_lshl_b32 s56, s51, 7
    buffer_load_dword v250, v246, s[40:43], s56 offen
L_nopre:
    s_mov_b64 exec, -1
    s_mov_b32 s101, 0
    s_cmp_lt_u32 s29, 28
    s_cbranch_scc1 L_Q2
    s_waitcnt vmcnt(0)
    s_mov_b32 s99, 0
    s_load_dword s98, s[26:27], s53 offset:0
    s_load_dword s99, s[26:27], s53 offset:8192
    s_waitcnt lgkmcnt(1)
    s_andn2_b32 s101, 0x100, s99
    s_branch L_Q2
.p2align 12
L_Q2:
    s_branch L_Q3
L_mlretry:
    s_sub_u32 s58, s58, 1
    s_cbranch_scc1 L_mlgo
    buffer_load_dwordx4 v[224:227], v230, s[32:35], s3 offen sc1
    s_waitcnt vmcnt(0)
    v_bitop3_b32 v247, v224, v225, s31 bitop3:0x7e
    v_bitop3_b32 v247, v226, s96, v247 bitop3:0xbe
    v_bitop3_b32 v247, v227, s97, v247 bitop3:0xbe
    v_cmp_ne_u32_sdwa s[4:5], v247, v246 src0_sel:BYTE_0 src1_sel:DWORD
    s_cmp_lg_u64 s[4:5], 0
    s_cbranch_scc1 L_mlretry
L_mlgo:
    s_mov_b32 s101, 1
    buffer_load_dwordx4 v[16:19], v231, s[32:35], s60 offen sc1
    buffer_load_dwordx4 v[20:23], v231, s[32:35], s61 offen sc1
    buffer_load_dwordx4 v[24:27], v231, s[32:35], s62 offen sc1
    buffer_load_dwordx4 v[28:31], v231, s[32:35], s63 offen sc1
    s_branch L_mldone
L_K2:
    s_nop 4
    v_and_b32 v204, v37, v164
    v_and_b32 v205, v37, v165
    v_and_b32 v206, v37, v166
    v_and_b32 v207, v37, v167
    v_mfma_f32_16x16x32_bf16 v[12:15], v[200:203], v[96:99], v[12:15]
    s_waitcnt vmcnt(5)
    s_xor_b32 s54, s99, 1064960
    buffer_load_dwordx4 v[128:131], v228, s[44:47], s54 offen offset:0 nt
    v_and_b32 v208, v41, v164
    v_and_b32 v209, v41, v165
    v_and_b32 v210, v41, v166
    v_and_b32 v211, v41, v167
    v_mfma_f32_16x16x32_bf16 v[12:15], v[204:207], v[100:103], v[12:15]
    v_and_b32 v212, v45, v164
    v_and_b32 v213, v45, v165
    v_and_b32 v214, v45, v166
    v_and_b32 v215, v45, v167
    v_mfma_f32_16x16x32_bf16 v[12:15], v[208:211], v[104:107], v[12:15]
    s_waitcnt vmcnt(5)
    s_xor_b32 s54, s99, 1069056
    buffer_load_dwordx4 v[132:135], v228, s[44:47], s54 offen offset:0 nt
    v_and_b32 v200, v34, v164
    v_and_b32 v201, v34, v165
    v_and_b32 v202, v34, v166
    v_and_b32 v203, v34, v167
    v_mfma_f32_16x16x32_bf16 v[12:15], v[212:215], v[108:111], v[12:15]
    s_waitcnt vmcnt(5)
    s_xor_b32 s54, s99, 1073152
    buffer_load_dwordx4 v[136:139], v228, s[44:47], s54 offen offset:0 nt
    v_and_b32 v204, v38, v164
    v_and_b32 v205, v38, v165
    v_and_b32 v206, v38, v166
    v_and_b32 v207, v38, v167
    v_mfma_f32_16x16x32_bf16 v[12:15], v[200:203], v[112:115], v[12:15]
    s_waitcnt vmcnt(5)
    s_mov_b64 exec, s[22:23]
    s_xor_b32 s54, s99, 1077248
    buffer_load_dwordx4 v[140:143], v228, s[44:47], s54 offen offset:0 nt
    s_mov_b64 exec, -1
    v_and_b32 v208, v42, v164
    v_and_b32 v209, v42, v165
    v_and_b32 v210, v42, v166
    v_and_b32 v211, v42, v167
    v_mfma_f32_16x16x32_bf16 v[12:15], v[204:207], v[116:119], v[12:15]
    s_waitcnt vmcnt(5)
    s_mov_b64 exec, s[22:23]
    s_xor_b32 s54, s99, 1077248
    buffer_load_dwordx4 v[144:147], v228, s[44:47], s54 offen offset:2048 nt
    s_mov_b64 exec, -1
    v_and_b32 v212, v46, v164
    v_and_b32 v213, v46, v165
    v_and_b32 v214, v46, v166
    v_and_b32 v215, v46, v167
    v_mfma_f32_16x16x32_bf16 v[12:15], v[208:211], v[120:123], v[12:15]
    s_waitcnt vmcnt(5)
    buffer_load_dwordx4 v[224:227], v230, s[32:35], s3 offen sc1
    v_and_b32 v200, v35, v164
    v_and_b32 v201, v35, v165
    v_and_b32 v202, v35, v166
    v_and_b32 v203, v35, v167
    v_mfma_f32_16x16x32_bf16 v[12:15], v[212:215], v[124:127], v[12:15]
    s_waitcnt vmcnt(5)
    buffer_load_dwordx4 v[168:171], v11, s[40:43], s48 offen nt
    s_add_u32 s48, s48, 7168
    v_and_b32 v204, v39, v164
    v_and_b32 v205, v39, v165
    v_and_b32 v206, v39, v166
    v_and_b32 v207, v39, v167
    v_mfma_f32_16x16x32_bf16 v[12:15], v[200:203], v[128:131], v[12:15]
    s_waitcnt vmcnt(5)
    buffer_load_dwordx4 v[172:175], v11, s[40:43], s48 offen nt
    s_add_u32 s48, s48, 7168
    v_and_b32 v208, v43, v164
    v_and_b32 v209, v43, v165
    v_and_b32 v210, v43, v166
    v_and_b32 v211, v43, v167
    v_mfma_f32_16x16x32_bf16 v[12:15], v[204:207], v[132:135], v[12:15]
    s_waitcnt vmcnt(5)
    buffer_load_dwordx4 v[176:179], v11, s[40:43], s48 offen nt
    s_add_u32 s48, s48, 7168
    v_and_b32 v212, v47, v164
    v_and_b32 v213, v47, v165
    v_and_b32 v214, v47, v166
    v_and_b32 v215, v47, v167
    v_mfma_f32_16x16x32_bf16 v[12:15], v[208:211], v[136:139], v[12:15]
    buffer_load_dwordx4 v[180:183], v11, s[40:43], s48 offen nt
    s_add_u32 s48, s48, 7168
    s_cmp_eq_u32 s60, 0
    s_cbranch_scc1 L_keep
    s_nop 3
    ds_write_b128 v238, v[12:15] offset:12288
    s_waitcnt lgkmcnt(0)
    s_barrier
    s_branch L_joined
L_keep:
    v_and_b32 v200, v48, v164
    v_and_b32 v201, v48, v165
    v_and_b32 v202, v48, v166
    v_and_b32 v203, v48, v167
    s_waitcnt vmcnt(6)
    v_mfma_f32_16x16x32_bf16 v[12:15], v[212:215], v[140:143], v[12:15]
    s_barrier
    ds_read_b128 v[4:7], v238 offset:12288
    s_waitcnt vmcnt(5)
    v_mfma_f32_16x16x32_bf16 v[12:15], v[200:203], v[144:147], v[12:15]
    s_waitcnt lgkmcnt(0)
    s_nop 6
    v_pk_add_f32 v[12:13], v[12:13], v[4:5]
    v_pk_add_f32 v[14:15], v[14:15], v[6:7]
    v_bfi_b32 v12, v244, v245, v12
    s_cmp_lg_u32 s59, 0
    s_cbranch_scc1 L_far1
    buffer_store_dwordx4 v[12:15], v229, s[32:35], s53 offen
L_back2:
L_joined:
    s_cmp_ge_u32 s29, 28
    s_cbranch_scc1 L_pf
    s_lshl_b32 s60, s28, 16
    s_and_b32 s56, s50, 3
    s_lshl_b32 s56, s56, 9
    s_add_u32 s60, s60, s56
    s_lshl_b32 s56, s30, 7
    s_add_u32 s60, s60, s56
    s_add_u32 s60, s60, 262144
    s_add_u32 s61, s60, 16384
    s_add_u32 s62, s60, 32768
    s_add_u32 s63, s60, 49152
    s_mov_b32 s58, 65536
    s_barrier
    s_mov_b32 s101, 0
    s_cmp_gt_u32 s30, 1
    s_cbranch_scc1 L_lf3
    s_waitcnt vmcnt(5)
    s_branch L_lf4
L_lf3:
    s_waitcnt vmcnt(4)
L_lf4:
    v_bitop3_b32 v247, v224, v225, s31 bitop3:0x7e
    v_bitop3_b32 v247, v226, s96, v247 bitop3:0xbe
    v_bitop3_b32 v247, v227, s97, v247 bitop3:0xbe
    v_cmp_ne_u32_sdwa s[4:5], v247, v246 src0_sel:BYTE_0 src1_sel:DWORD
    s_cmp_lg_u64 s[4:5], 0
    s_cbranch_scc1 L_mlretry
L_mldone:
    s_cmp_ge_u32 s50, 2
    s_cselect_b64 vcc, -1, 0
    v_cndmask_b32 v4, v224, v226, vcc
    v_cndmask_b32 v5, v225, v227, vcc
    v_and_b32 v4, 0xffff0000, v4
    v_and_b32 v5, 0xffffff00, v5
    v_mov_b32 v6, v4
    s_nop 1
    v_max_f32_dpp v6, v6, v6 quad_perm:[1,0,3,2] row_mask:0xf bank_mask:0xf
    s_nop 1
    v_max_f32_dpp v6, v6, v6 quad_perm:[2,3,0,1] row_mask:0xf bank_mask:0xf
    s_nop 1
    v_max_f32_dpp v6, v6, v6 row_half_mirror row_mask:0xf bank_mask:0xf
    v_mov_b32 v7, v6
    s_nop 1
    v_permlane16_swap_b32 v6, v7
    v_max_f32 v6, v6, v7
    v_mov_b32 v7, v6
    s_nop 1
    v_permlane32_swap_b32 v6, v7
    v_max_f32 v6, v6, v7
    v_sub_f32 v4, v4, v6
    v_mul_f32 v4, s57, v4
    v_exp_f32 v4, v4
    s_nop 0
    v_mul_f32 v6, v4, v5
    s_nop 1
    v_add_f32_dpp v6, v6, v6 quad_perm:[1,0,3,2] row_mask:0xf bank_mask:0xf
    s_nop 1
    v_add_f32_dpp v6, v6, v6 quad_perm:[2,3,0,1] row_mask:0xf bank_mask:0xf
    s_nop 1
    v_add_f32_dpp v6, v6, v6 row_half_mirror row_mask:0xf bank_mask:0xf
    v_mov_b32 v7, v6
    s_nop 1
    v_permlane16_swap_b32 v6, v7
    v_add_f32 v6, v6, v7
    v_mov_b32 v7, v6
    s_nop 1
    v_permlane32_swap_b32 v6, v7
    v_add_f32 v6, v6, v7
    v_rcp_f32 v6, v6
    s_nop 0
    v_mul_f32 v4, v4, v6
    s_nop 1
    v_mov_b32_dpp v32, v4 quad_perm:[0,0,0,0] row_mask:0xf bank_mask:0xf
    v_mov_b32_dpp v33, v4 quad_perm:[1,1,1,1] row_mask:0xf bank_mask:0xf
    v_mov_b32_dpp v34, v4 quad_perm:[2,2,2,2] row_mask:0xf bank_mask:0xf
    v_mov_b32_dpp v35, v4 quad_perm:[3,3,3,3] row_mask:0xf bank_mask:0xf
    s_cmp_lg_u32 s101, 0
    s_cbranch_scc1 L_opsent
    s_cmp_gt_u32 s30, 1
    s_cbranch_scc1 L_lf5
    s_waitcnt vmcnt(2)
    s_branch L_lf6
L_lf5:
    s_waitcnt vmcnt(1)
L_lf6:
    buffer_load_dwordx4 v[16:19], v231, s[32:35], s60 offen sc1
    buffer_load_dwordx4 v[20:23], v231, s[32:35], s61 offen sc1
    buffer_load_dwordx4 v[24:27], v231, s[32:35], s62 offen sc1
    buffer_load_dwordx4 v[28:31], v231, s[32:35], s63 offen sc1
L_opsent:
    s_branch L_chk8
L_poll7:
    s_sub_u32 s58, s58, 1
    s_cbranch_scc1 L_pdone9
    s_wqm_b64 exec, s[4:5]
    buffer_load_dwordx4 v[16:19], v231, s[32:35], s60 offen sc1
    s_wqm_b64 exec, s[6:7]
    buffer_load_dwordx4 v[20:23], v231, s[32:35], s61 offen sc1
    s_wqm_b64 exec, s[8:9]
    buffer_load_dwordx4 v[24:27], v231, s[32:35], s62 offen sc1
    s_wqm_b64 exec, s[10:11]
    buffer_load_dwordx4 v[28:31], v231, s[32:35], s63 offen sc1
    s_mov_b64 exec, -1
L_chk8:
    s_waitcnt vmcnt(3)
    v_cmp_ne_u32_sdwa s[4:5], v16, v245 src0_sel:BYTE_0 src1_sel:DWORD
    v_and_b32 v44, 0xffffff00, v16
    v_pk_mul_f32 v[38:39], v[18:19], v[32:33] op_sel:[0,0] op_sel_hi:[1,0]
    v_mul_f32 v37, v17, v32
    v_mul_f32 v36, v44, v32
    s_waitcnt vmcnt(2)
    v_cmp_ne_u32_sdwa s[6:7], v20, v245 src0_sel:BYTE_0 src1_sel:DWORD
    v_and_b32 v44, 0xffffff00, v20
    v_pk_fma_f32 v[38:39], v[22:23], v[32:33], v[38:39] op_sel:[0,1,0] op_sel_hi:[1,1,1]
    v_fmac_f32 v37, v21, v33
    v_fmac_f32 v36, v44, v33
    s_or_b64 vcc, s[4:5], s[6:7]
    s_waitcnt vmcnt(1)
    v_cmp_ne_u32_sdwa s[8:9], v24, v245 src0_sel:BYTE_0 src1_sel:DWORD
    v_and_b32 v44, 0xffffff00, v24
    v_pk_fma_f32 v[38:39], v[26:27], v[34:35], v[38:39] op_sel:[0,0,0] op_sel_hi:[1,0,1]
    v_fmac_f32 v37, v25, v34
    v_fmac_f32 v36, v44, v34
    s_or_b64 vcc, vcc, s[8:9]
    s_waitcnt vmcnt(0)
    v_cmp_ne_u32_sdwa s[10:11], v28, v245 src0_sel:BYTE_0 src1_sel:DWORD
    s_or_b64 vcc, vcc, s[10:11]
    s_cbranch_scc1 L_poll7
L_pdone9:
    s_barrier
    global_load_dwordx4 v[184:187], v[216:217], off nt
    v_and_b32 v44, 0xffffff00, v28
    v_pk_fma_f32 v[38:39], v[30:31], v[34:35], v[38:39] op_sel:[0,1,0] op_sel_hi:[1,1,1]
    v_fmac_f32 v37, v29, v35
    v_fmac_f32 v36, v44, v35
    global_load_dwordx4 v[188:191], v[218:219], off nt
    global_load_dwordx4 v[192:195], v[220:221], off nt
    v_permlane32_swap_b32 v36, v38
    v_permlane32_swap_b32 v37, v39
    v_add_f32 v36, v36, v38
    v_add_f32 v37, v37, v39
    s_nop 1
    v_permlane16_swap_b32 v36, v37
    v_add_f32 v36, v36, v37
    global_load_dwordx4 v[196:199], v[222:223], off nt
    s_nop 0
    v_add_f32_dpp v37, v36, v36 row_shr:4 row_mask:0xf bank_mask:0xa
    s_nop 1
    v_add_f32_dpp v37, v36, v36 row_shl:4 row_mask:0xf bank_mask:0x5
    v_cvt_pk_bf16_f32 v37, v37, v37
    s_nop 1
    v_and_b32_dpp v200, v37, v164 quad_perm:[0,0,0,0] row_mask:0xf bank_mask:0xf
    v_and_b32_dpp v201, v37, v165 quad_perm:[0,0,0,0] row_mask:0xf bank_mask:0xf
    v_and_b32_dpp v202, v37, v166 quad_perm:[0,0,0,0] row_mask:0xf bank_mask:0xf
    v_and_b32_dpp v203, v37, v167 quad_perm:[0,0,0,0] row_mask:0xf bank_mask:0xf
    v_and_b32_dpp v204, v37, v164 quad_perm:[1,1,1,1] row_mask:0xf bank_mask:0xf
    v_and_b32_dpp v205, v37, v165 quad_perm:[1,1,1,1] row_mask:0xf bank_mask:0xf
    v_and_b32_dpp v206, v37, v166 quad_perm:[1,1,1,1] row_mask:0xf bank_mask:0xf
    v_and_b32_dpp v207, v37, v167 quad_perm:[1,1,1,1] row_mask:0xf bank_mask:0xf
    v_mfma_f32_16x16x32_bf16 v[40:43], v[200:203], v[168:171], 0
    v_and_b32_dpp v208, v37, v164 quad_perm:[2,2,2,2] row_mask:0xf bank_mask:0xf
    v_and_b32_dpp v209, v37, v165 quad_perm:[2,2,2,2] row_mask:0xf bank_mask:0xf
    v_and_b32_dpp v210, v37, v166 quad_perm:[2,2,2,2] row_mask:0xf bank_mask:0xf
    v_and_b32_dpp v211, v37, v167 quad_perm:[2,2,2,2] row_mask:0xf bank_mask:0xf
    v_mfma_f32_16x16x32_bf16 v[40:43], v[204:207], v[172:175], v[40:43]
    v_and_b32_dpp v212, v37, v164 quad_perm:[3,3,3,3] row_mask:0xf bank_mask:0xf
    v_and_b32_dpp v213, v37, v165 quad_perm:[3,3,3,3] row_mask:0xf bank_mask:0xf
    v_and_b32_dpp v214, v37, v166 quad_perm:[3,3,3,3] row_mask:0xf bank_mask:0xf
    v_and_b32_dpp v215, v37, v167 quad_perm:[3,3,3,3] row_mask:0xf bank_mask:0xf
    v_mfma_f32_16x16x32_bf16 v[40:43], v[208:211], v[176:179], v[40:43]
    s_nop 0
    v_mfma_f32_16x16x32_bf16 v[40:43], v[212:215], v[180:183], v[40:43]
    s_mov_b32 exec_lo, 0x00ff00ff
    s_mov_b32 exec_hi, 0xff00ff00
    s_nop 5
    ds_write_b128 v232, v[40:43] offset:5120
    s_mov_b64 exec, -1
    s_waitcnt lgkmcnt(0)
    s_barrier
    s_lshl_b32 s56, s30, 11
    s_cmp_ge_u32 s52, 28
    s_cbranch_scc1 L_end
L_finback:
    v_mov_b32 v16, 0x3f803f80
    s_mul_i32 s60, s51, 16384
    s_add_u32 s60, s60, s56
    s_add_u32 s60, s60, 1179648
    v_and_b32 v17, 0x100, v224
    v_cmp_ne_u32 vcc, 0, v17
    s_bcnt1_i32_b64 s56, vcc
    s_cmp_lt_u32 s56, 4
    s_cselect_b32 s56, 8192, 0
    s_add_u32 s60, s60, s56
    v_mov_b32 v17, s56
    ds_write_b32 v246, v17 offset:11280
    s_add_u32 s61, s60, 1024
    s_lshl_b32 s62, s52, 11
    s_add_u32 s62, s62, 786432
    s_mov_b32 s63, 0xffff0000
    v_and_b32 v200, v16, v164
    v_and_b32 v201, v16, v165
    v_and_b32 v202, v16, v166
    v_and_b32 v203, v16, v167
    v_and_b32 v204, v16, v164
    v_and_b32 v205, v16, v165
    v_and_b32 v206, v16, v166
    v_and_b32 v207, v16, v167
    v_and_b32 v208, v16, v164
    v_and_b32 v209, v16, v165
    v_and_b32 v210, v16, v166
    v_and_b32 v211, v16, v167
    v_and_b32 v212, v16, v164
    v_and_b32 v213, v16, v165
    v_and_b32 v214, v16, v166
    v_and_b32 v215, v16, v167
    v_mov_b32 v20, v245
    v_mov_b32 v21, 0
    v_mov_b32 v22, 0
    v_mov_b32 v23, 0
    v_lshlrev_b32 v1, 4, v0
    s_mov_b64 s[4:5], -1
    s_mov_b64 s[6:7], -1
    s_mov_b32 s58, 65536
    v_mov_b32 v16, 0
    v_mov_b32 v17, 0
    v_mov_b32 v18, 0
    v_mov_b32 v19, 0
    s_waitcnt vmcnt(2)
    s_mov_b64 exec, s[4:5]
    buffer_load_dwordx4 v[48:51], v236, s[32:35], s60 offen sc1
    s_mov_b64 exec, s[6:7]
    buffer_load_dwordx4 v[52:55], v236, s[32:35], s61 offen sc1
    s_mov_b64 exec, -1
    s_waitcnt vmcnt(2)
    s_mov_b64 exec, s[4:5]
    buffer_load_dwordx4 v[56:59], v236, s[32:35], s60 offen sc1
    s_mov_b64 exec, s[6:7]
    buffer_load_dwordx4 v[60:63], v236, s[32:35], s61 offen sc1
    s_mov_b64 exec, -1
L_ps14:
    s_waitcnt vmcnt(3)
    v_cmp_ne_u32_sdwa vcc, v48, v245 src0_sel:BYTE_0 src1_sel:DWORD
    v_and_b32 v48, 0xffffff00, v48
    s_wqm_b64 vcc, vcc
    s_andn2_b64 exec, s[4:5], vcc
    s_and_b64 s[4:5], s[4:5], vcc
    v_pk_add_f32 v[16:17], v[16:17], v[48:49]
    v_pk_add_f32 v[18:19], v[18:19], v[50:51]
    s_mov_b64 exec, -1
    s_waitcnt vmcnt(2)
    v_cmp_ne_u32_sdwa vcc, v52, v245 src0_sel:BYTE_0 src1_sel:DWORD
    v_and_b32 v52, 0xffffff00, v52
    s_wqm_b64 vcc, vcc
    s_andn2_b64 exec, s[6:7], vcc
    s_and_b64 s[6:7], s[6:7], vcc
    v_pk_add_f32 v[16:17], v[16:17], v[52:53]
    v_pk_add_f32 v[18:19], v[18:19], v[54:55]
    s_mov_b64 exec, -1
    s_or_b64 vcc, s[4:5], s[6:7]
    s_cbranch_scc0 L_psd15
    s_mov_b64 exec, s[4:5]
    buffer_load_dwordx4 v[48:51], v236, s[32:35], s60 offen sc1
    s_mov_b64 exec, s[6:7]
    buffer_load_dwordx4 v[52:55], v236, s[32:35], s61 offen sc1
    s_mov_b64 exec, -1
    s_waitcnt vmcnt(3)
    v_cmp_ne_u32_sdwa vcc, v56, v245 src0_sel:BYTE_0 src1_sel:DWORD
    v_and_b32 v56, 0xffffff00, v56
    s_wqm_b64 vcc, vcc
    s_andn2_b64 exec, s[4:5], vcc
    s_and_b64 s[4:5], s[4:5], vcc
    v_pk_add_f32 v[16:17], v[16:17], v[56:57]
    v_pk_add_f32 v[18:19], v[18:19], v[58:59]
    s_mov_b64 exec, -1
    s_waitcnt vmcnt(2)
    v_cmp_ne_u32_sdwa vcc, v60, v245 src0_sel:BYTE_0 src1_sel:DWORD
    v_and_b32 v60, 0xffffff00, v60
    s_wqm_b64 vcc, vcc
    s_andn2_b64 exec, s[6:7], vcc
    s_and_b64 s[6:7], s[6:7], vcc
    v_pk_add_f32 v[16:17], v[16:17], v[60:61]
    v_pk_add_f32 v[18:19], v[18:19], v[62:63]
    s_mov_b64 exec, -1
    s_or_b64 vcc, s[4:5], s[6:7]
    s_cbranch_scc0 L_psd15
    s_mov_b64 exec, s[4:5]
    buffer_load_dwordx4 v[56:59], v236, s[32:35], s60 offen sc1
    s_mov_b64 exec, s[6:7]
    buffer_load_dwordx4 v[60:63], v236, s[32:35], s61 offen sc1
    s_mov_b64 exec, -1
    s_sub_u32 s58, s58, 1
    s_cbranch_scc0 L_ps14
L_psd15:
    ds_write_b32 v246, v244 offset:11296
    v_permlane32_swap_b32 v16, v18
    v_permlane32_swap_b32 v17, v19
    v_add_f32 v16, v16, v18
    v_add_f32 v17, v17, v19
    s_nop 1
    v_permlane16_swap_b32 v16, v17
    v_add_f32 v16, v16, v17
    s_nop 1
    v_add_f32_dpp v16, v16, v16 row_ror:4 row_mask:0xf bank_mask:0xf
    s_nop 1
    v_add_f32_dpp v16, v16, v16 row_ror:8 row_mask:0xf bank_mask:0xf
    v_cvt_pk_bf16_f32 v16, v16, v16
    v_and_b32 v16, 0xffff0000, v16
    v_add_f32 v16, v16, v233
    v_cvt_pk_bf16_f32 v16, v16, v16
    v_and_or_b32 v17, v16, s63, v8
    s_nop 0
    v_and_b32_dpp v200, v16, v164 quad_perm:[0,0,0,0] row_mask:0xf bank_mask:0x3
    v_and_b32_dpp v201, v16, v165 quad_perm:[0,0,0,0] row_mask:0xf bank_mask:0x3
    v_and_b32_dpp v202, v16, v166 quad_perm:[0,0,0,0] row_mask:0xf bank_mask:0x3
    v_and_b32_dpp v203, v16, v167 quad_perm:[0,0,0,0] row_mask:0xf bank_mask:0x3
    v_and_b32_dpp v204, v16, v164 quad_perm:[1,1,1,1] row_mask:0xf bank_mask:0x3
    v_and_b32_dpp v205, v16, v165 quad_perm:[1,1,1,1] row_mask:0xf bank_mask:0x3
    v_and_b32_dpp v206, v16, v166 quad_perm:[1,1,1,1] row_mask:0xf bank_mask:0x3
    v_and_b32_dpp v207, v16, v167 quad_perm:[1,1,1,1] row_mask:0xf bank_mask:0x3
    v_mfma_f32_16x16x32_bf16 v[40:43], v[200:203], v[184:187], 0
    v_and_b32_dpp v208, v16, v164 quad_perm:[2,2,2,2] row_mask:0xf bank_mask:0x3
    v_and_b32_dpp v209, v16, v165 quad_perm:[2,2,2,2] row_mask:0xf bank_mask:0x3
    v_and_b32_dpp v210, v16, v166 quad_perm:[2,2,2,2] row_mask:0xf bank_mask:0x3
    v_and_b32_dpp v211, v16, v167 quad_perm:[2,2,2,2] row_mask:0xf bank_mask:0x3
    v_mfma_f32_16x16x32_bf16 v[40:43], v[204:207], v[188:191], v[40:43]
    v_and_b32_dpp v212, v16, v164 quad_perm:[3,3,3,3] row_mask:0xf bank_mask:0x3
    v_and_b32_dpp v213, v16, v165 quad_perm:[3,3,3,3] row_mask:0xf bank_mask:0x3
    v_and_b32_dpp v214, v16, v166 quad_perm:[3,3,3,3] row_mask:0xf bank_mask:0x3
    v_and_b32_dpp v215, v16, v167 quad_perm:[3,3,3,3] row_mask:0xf bank_mask:0x3
    v_mfma_f32_16x16x32_bf16 v[40:43], v[208:211], v[192:195], v[40:43]
    s_nop 0
    v_mfma_f32_16x16x32_bf16 v[40:43], v[212:215], v[196:199], v[40:43]
    ds_write_b32 v234, v17 offset:11776
    s_nop 6
    ds_write_b128 v237, v[40:43] offset:7168
    s_cmp_lg_u32 s59, 0
    s_cbranch_scc1 L_far16
    buffer_store_dword v17, v235, s[32:35], s62 offen
L_back17:
    s_waitcnt lgkmcnt(0)
    s_barrier
    s_cmp_lg_u32 s30, 1
    s_cbranch_scc1 L_end
    s_mov_b64 s[4:5], -1
    s_mov_b32 s6, 4294967295
    s_mov_b32 s7, 65535
    s_mov_b32 s58, 65536
L_poll18:
    s_sub_u32 s58, s58, 1
    s_cbranch_scc1 L_pdone20
    s_wqm_b64 exec, s[4:5]
    buffer_load_dwordx4 v[16:19], v1, s[32:35], s62 offen sc1
    s_wqm_b64 exec, s[6:7]
    buffer_load_dwordx4 v[20:23], v1, s[32:35], s62 offen offset:1024 sc1
    s_mov_b64 exec, -1
    s_waitcnt vmcnt(1)
    v_cmp_ne_u32_sdwa s[4:5], v16, v245 src0_sel:BYTE_0 src1_sel:DWORD
    s_waitcnt vmcnt(0)
    v_cmp_ne_u32_sdwa s[6:7], v20, v245 src0_sel:BYTE_0 src1_sel:DWORD
    s_or_b64 vcc, s[4:5], s[6:7]
    s_cbranch_scc1 L_poll18
L_pdone20:
    v_and_b32 v16, 0xffffff00, v16
    v_and_b32 v20, 0xffffff00, v20
    v_pk_add_f32 v[28:29], v[18:19], v[22:23]
    v_pk_mul_f32 v[30:31], v[18:19], v[18:19]
    v_pk_add_f32 v[28:29], v[28:29], v[16:17]
    v_pk_fma_f32 v[30:31], v[22:23], v[22:23], v[30:31]
    v_pk_add_f32 v[28:29], v[28:29], v[20:21]
    v_pk_fma_f32 v[30:31], v[16:17], v[16:17], v[30:31]
    v_add_f32 v40, v28, v29
    v_pk_fma_f32 v[30:31], v[20:21], v[20:21], v[30:31]
    v_add_f32 v41, v30, v31
    s_nop 1
    v_permlane32_swap_b32 v40, v41
    v_add_f32 v40, v40, v41
    s_nop 1
    v_add_f32_dpp v40, v40, v40 row_ror:8 row_mask:0xf bank_mask:0xf
    s_nop 1
    v_add_f32_dpp v40, v40, v40 row_ror:4 row_mask:0xf bank_mask:0xf
    s_nop 1
    v_add_f32_dpp v40, v40, v40 row_ror:2 row_mask:0xf bank_mask:0xf
    s_nop 1
    v_add_f32_dpp v40, v40, v40 row_ror:1 row_mask:0xf bank_mask:0xf
    s_nop 1
    v_add_f32_dpp v40, v40, v40 row_bcast:15 row_mask:0xa bank_mask:0xf
    v_mul_f32 v40, 991054117, v40
    s_nop 0
    v_readlane_b32 s56, v40, 16
    s_brev_b64 exec, 1
    s_nop 0
    v_fma_f32 v41, -s56, s56, v40
    v_max_f32 v41, 0, v41
    v_cvt_pk_bf16_f32 v41, s56, v41
    v_lshlrev_b32 v40, 16, v41
    v_and_b32 v41, 0xffff0000, v41
    v_add_f32 v41, 925353388, v41
    v_cvt_pk_bf16_f32 v41, v41, v41
    v_and_b32 v41, 0xffff0000, v41
    v_sqrt_f32 v41, v41
    s_nop 0
    v_cvt_pk_bf16_f32 v41, v41, v41
    v_and_b32 v41, 0xffff0000, v41
    v_rcp_f32 v41, v41
    ds_write_b64 v246, v[40:41] offset:11288
    s_waitcnt lgkmcnt(0)
    s_barrier
    s_cmp_lg_u32 s28, 6
    s_cbranch_scc1 L_nowb
    s_cmp_lg_u32 s29, 7
    s_cbranch_scc1 L_nowb
    buffer_wbl2 sc1
    s_waitcnt vmcnt(0)
L_nowb:
    s_cmp_lg_u32 s2, 0
    s_cbranch_scc1 L_end
    s_mov_b64 exec, 1
    v_mov_b32 v16, s31
    buffer_store_dword v16, v246, s[32:35], 0 offen
L_end:
    s_endpgm
L_qpub:
    v_lshlrev_b32 v204, 4, v0
    s_mov_b64 exec, 0xffff
    ds_read_b128 v[200:203], v204 offset:12032
    s_lshr_b32 s56, s29, 2
    s_xor_b32 s56, s56, 4
    s_and_b32 s54, s29, 3
    s_lshl_b32 s54, s54, 11
    s_lshl_b32 s56, s56, 8
    s_add_u32 s56, s56, s54
    s_lshl_b32 s54, s28, 13
    s_add_u32 s56, s56, s54
    s_add_u32 s56, s56, 65536
    s_waitcnt lgkmcnt(0)
    v_bitop3_b32 v205, v200, v201, s31 bitop3:0x7e
    v_bitop3_b32 v205, v202, s96, v205 bitop3:0xbe
    v_bitop3_b32 v205, v203, s63, v205 bitop3:0xbe
    v_cmp_eq_u32_sdwa vcc, v205, v246 src0_sel:BYTE_0 src1_sel:DWORD
    s_mov_b64 exec, vcc
    buffer_store_dwordx4 v[200:203], v204, s[32:35], s56 offen sc1
    s_mov_b64 exec, -1
    s_branch L_qback
L_pf:
    s_sub_u32 s50, s29, 28
    s_and_b32 s56, s52, 7
    s_lshl_b32 s60, s50, 3
    s_add_u32 s60, s60, s56
    s_cmp_ge_u32 s60, 28
    s_cbranch_scc1 L_end
    s_mul_i32 s60, s56, 3
    s_min_u32 s56, s56, 4
    s_add_u32 s60, s60, s56
    s_add_u32 s60, s60, s50
    s_mul_i32 s60, s60, 57344
    s_mul_i32 s56, s30, 7168
    s_add_u32 s61, s60, s56
    s_add_u32 s60, s61, 28672
    s_add_u32 s61, s61, 0
    v_lshlrev_b32 v1, 7, v0
    s_mov_b64 s[44:45], s[20:21]
    s_mov_b32 s46, 1605632
    s_mov_b32 s47, 0x00020000
    s_cmp_lg_u32 s30, 0
    s_cbranch_scc1 L_pfgo
    v_and_b32 v2, 31, v0
    v_lshlrev_b32 v2, 11, v2
    v_lshrrev_b32 v3, 5, v0
    v_lshl_add_u32 v2, v3, 9, v2
    v_mov_b32 v6, s31
    s_lshl_b32 s62, s28, 16
    s_add_u32 s62, s62, 262144
    s_mov_b32 s58, 64
L_pfpoll:
    s_sub_u32 s58, s58, 1
    s_cbranch_scc1 L_pfgo
    buffer_load_dword v3, v2, s[32:35], s62 offen sc1
    s_waitcnt vmcnt(0)
    v_cmp_eq_u32_sdwa vcc, v3, v6 src0_sel:BYTE_0 src1_sel:BYTE_0
    s_bcnt1_i32_b64 s56, vcc
    s_cmp_lt_u32 s56, 40
    s_cbranch_scc1 L_pfpoll
L_pfgo:
    s_barrier
    s_mov_b32 exec_lo, 4294967295
    s_mov_b32 exec_hi, 16777215
    buffer_load_dword v5, v1, s[44:47], s61 offen
    s_mov_b32 exec_lo, -1
    s_mov_b32 exec_hi, 0xffffff
    buffer_load_dword v4, v1, s[44:47], s60 offen
    s_waitcnt vmcnt(0)
    s_branch L_end
.p2align 12
L_Q3:
    s_barrier
    ds_read_b128 v[24:27], v246 offset:11264
    s_waitcnt lgkmcnt(0)
    v_or3_b32 v24, v24, v25, v26
    v_or_b32 v24, v24, v27
    s_nop 0
    v_readfirstlane_b32 s59, v24
    s_cmp_lg_u32 s59, 0
    s_cbranch_scc1 L_qfar
L_qnear:
    s_setprio 3
    s_barrier
    ds_read_b128 v[16:19], v72 offset:11520
    ds_read_b128 v[20:23], v72 offset:11552
    s_waitcnt lgkmcnt(0)
    v_max3_f32 v8, v16, v17, v18
    v_max_f32 v8, v8, v19
    v_sub_f32 v16, v16, v8
    v_sub_f32 v17, v17, v8
    v_sub_f32 v18, v18, v8
    v_sub_f32 v19, v19, v8
    v_mul_f32 v16, s57, v16
    v_mul_f32 v17, s57, v17
    v_mul_f32 v18, s57, v18
    v_mul_f32 v19, s57, v19
    v_exp_f32 v16, v16
    v_exp_f32 v17, v17
    v_exp_f32 v18, v18
    v_exp_f32 v19, v19
    v_mul_f32 v9, v16, v20
    v_fmac_f32 v9, v17, v21
    v_fmac_f32 v9, v18, v22
    v_fmac_f32 v9, v19, v23
    v_mov_b32_dpp v10, v8 quad_perm:[1,1,1,1] row_mask:0xf bank_mask:0xf
    s_nop 0
    v_mov_b32_dpp v11, v9 quad_perm:[1,1,1,1] row_mask:0xf bank_mask:0xf
    v_or_b32 v8, s101, v8
    v_bfi_b32 v8, v245, s31, v8
    v_bfi_b32 v9, v245, s31, v9
    v_bfi_b32 v10, v245, s96, v10
    v_bfi_b32 v11, v245, s97, v11
    s_cmp_lg_u32 s59, 0
    s_cbranch_scc1 L_far23
    buffer_store_dwordx4 v[8:11], v14, s[32:35], s60 offen
L_back24:
    s_cmp_ge_u32 s29, 28
    s_cbranch_scc1 L_end
    s_setprio 0
    ds_write_b32 v246, v246 offset:11296
    s_waitcnt lgkmcnt(0)
    s_add_u32 s53, s49, 8192
    s_barrier
    s_barrier
    s_barrier
    s_setprio 3
    s_barrier
    ds_read2st64_b32 v[16:17], v2 offset0:20 offset1:21
    ds_read2st64_b32 v[18:19], v2 offset0:22 offset1:23
    ds_read2st64_b32 v[20:21], v2 offset0:24 offset1:25
    ds_read2st64_b32 v[22:23], v2 offset0:26 offset1:27
    s_waitcnt lgkmcnt(2)
    v_pk_add_f32 v[16:17], v[16:17], v[18:19]
    s_waitcnt lgkmcnt(0)
    v_pk_add_f32 v[20:21], v[20:21], v[22:23]
    v_pk_add_f32 v[16:17], v[16:17], v[20:21]
    v_add_f32 v16, v16, v17
    v_bfi_b32 v16, v243, v15, v16
    buffer_store_dword v16, v252, s[32:35], s49 offen sc1
    buffer_store_dword v16, v252, s[32:35], s53 offen sc1
    s_setprio 0
    s_cmp_ge_u32 s52, 28
    s_cbranch_scc1 L_end
    v_mov_b32 v84, v244
    v_mov_b32 v85, 0
    v_mov_b32 v86, 0
    v_mov_b32 v87, 0
    s_add_u32 s56, s51, 1
    s_sub_u32 s60, s56, 7
    s_cselect_b32 s56, s56, s60
    s_lshl_b32 s56, s56, 10
    s_add_u32 s20, s56, s61
    s_add_u32 s56, s51, 2
    s_sub_u32 s60, s56, 7
    s_cselect_b32 s56, s56, s60
    s_lshl_b32 s56, s56, 10
    s_add_u32 s21, s56, s61
    s_add_u32 s56, s51, 3
    s_sub_u32 s60, s56, 7
    s_cselect_b32 s56, s56, s60
    s_lshl_b32 s56, s56, 10
    s_add_u32 s22, s56, s61
    s_add_u32 s56, s51, 4
    s_sub_u32 s60, s56, 7
    s_cselect_b32 s56, s56, s60
    s_lshl_b32 s56, s56, 10
    s_add_u32 s23, s56, s61
    s_add_u32 s56, s51, 5
    s_sub_u32 s60, s56, 7
    s_cselect_b32 s56, s56, s60
    s_lshl_b32 s56, s56, 10
    s_add_u32 s24, s56, s61
    s_add_u32 s56, s51, 6
    s_sub_u32 s60, s56, 7
    s_cselect_b32 s56, s56, s60
    s_lshl_b32 s56, s56, 10
    s_add_u32 s25, s56, s61
    s_mul_i32 s54, s51, 16384
    s_add_u32 s54, s54, 1310720
    s_lshl_b32 s56, s52, 8
    s_add_u32 s49, s54, s56
    v_cmp_gt_u32 vcc, 16, v0
    s_nop 1
    v_cndmask_b32 v4, v12, v1, vcc
    s_cmp_eq_u32 s28, 6
    s_cselect_b32 s50, s50, 4
    s_lshl_b32 s56, s50, 6
    s_add_u32 s54, s54, s56
    s_add_u32 s53, s54, 4096
    v_lshrrev_b32 v7, 2, v0
    v_lshlrev_b32 v7, 8, v7
    v_lshl_add_u32 v7, v3, 4, v7
    v_lshl_add_u32 v8, v3, 2, v5
    v_lshl_add_u32 v9, v8, 2, s56
    v_and_b32 v9, 0xff, v9
    v_lshlrev_b32 v8, 1, v8
    v_and_b32 v10, 12, v0
    v_cmp_eq_u32 vcc, 0, v10
    s_nop 1
    v_cndmask_b32 v8, v12, v8, vcc
    s_lshl_b32 s55, s51, 7
    s_lshl_b32 s56, s50, 5
    s_add_u32 s55, s55, s56
    v_bfe_u32 v76, v0, 3, 1
    v_mul_u32_u24 v74, 0x0606, v76
    v_mul_u32_u24 v75, 0x0202, v76
    v_lshlrev_b32 v74, 16, v74
    v_lshlrev_b32 v75, 16, v75
    v_add_u32 v74, 0x01000c0c, v74
    v_sub_u32 v75, 0x05040c0c, v75
    v_mov_b32 v76, 3184710632
    s_mov_b32 s56, 0x05040100
    s_mov_b32 s60, 0x07060302
    s_mov_b32 s58, 1048576
L_fwait:
    ds_read_b32 v11, v246 offset:11296
    s_sub_u32 s58, s58, 1
    s_cbranch_scc1 L_fgo
    s_waitcnt lgkmcnt(0)
    v_cmp_eq_u32 vcc, 0, v11
    s_cbranch_vccnz L_fwait
L_fgo:
    buffer_load_dwordx2 v[128:129], v6, s[44:47], s48 offen offset:0 nt
    buffer_load_dwordx2 v[144:145], v6, s[44:47], s48 offen offset:896 nt
    s_add_u32 s48, s48, 7168
    buffer_load_dwordx2 v[130:131], v6, s[44:47], s48 offen offset:0 nt
    buffer_load_dwordx2 v[146:147], v6, s[44:47], s48 offen offset:896 nt
    s_add_u32 s48, s48, 7168
    buffer_load_dwordx2 v[132:133], v6, s[44:47], s48 offen offset:0 nt
    buffer_load_dwordx2 v[148:149], v6, s[44:47], s48 offen offset:896 nt
    s_add_u32 s48, s48, 7168
    buffer_load_dwordx2 v[134:135], v6, s[44:47], s48 offen offset:0 nt
    buffer_load_dwordx2 v[150:151], v6, s[44:47], s48 offen offset:896 nt
    s_add_u32 s48, s48, 7168
    buffer_load_dwordx2 v[136:137], v6, s[44:47], s48 offen offset:0 nt
    buffer_load_dwordx2 v[152:153], v6, s[44:47], s48 offen offset:896 nt
    s_add_u32 s48, s48, 7168
    buffer_load_dwordx2 v[138:139], v6, s[44:47], s48 offen offset:0 nt
    buffer_load_dwordx2 v[154:155], v6, s[44:47], s48 offen offset:896 nt
    s_add_u32 s48, s48, 7168
    buffer_load_dwordx2 v[140:141], v6, s[44:47], s48 offen offset:0 nt
    buffer_load_dwordx2 v[156:157], v6, s[44:47], s48 offen offset:896 nt
    s_add_u32 s48, s48, 7168
    buffer_load_dwordx2 v[142:143], v6, s[44:47], s48 offen offset:0 nt
    buffer_load_dwordx2 v[158:159], v6, s[44:47], s48 offen offset:896 nt
L_nodn25:
    s_mov_b32 s58, 65536
    s_setprio 3
    s_barrier
    ds_read_b128 v[24:27], v1 offset:7168
    ds_read_b128 v[28:31], v1 offset:8192
    ds_read_b128 v[32:35], v1 offset:9216
    ds_read_b128 v[36:39], v1 offset:10240
    s_waitcnt lgkmcnt(2)
    v_pk_add_f32 v[24:25], v[24:25], v[28:29]
    v_pk_add_f32 v[26:27], v[26:27], v[30:31]
    s_waitcnt lgkmcnt(0)
    v_pk_add_f32 v[32:33], v[32:33], v[36:37]
    v_pk_add_f32 v[34:35], v[34:35], v[38:39]
    v_pk_add_f32 v[24:25], v[24:25], v[32:33]
    v_pk_add_f32 v[26:27], v[26:27], v[34:35]
    v_bfi_b32 v24, v245, v244, v24
    s_cmp_lg_u32 s59, 0
    s_cbranch_scc1 L_far26
    buffer_store_dwordx4 v[24:27], v1, s[32:35], s62 offen
L_back27:
    buffer_load_dwordx4 v[44:47], v1, s[32:35], s20 offen sc1
    buffer_load_dwordx4 v[48:51], v1, s[32:35], s21 offen sc1
    buffer_load_dwordx4 v[52:55], v1, s[32:35], s22 offen sc1
    buffer_load_dwordx4 v[56:59], v1, s[32:35], s23 offen sc1
    buffer_load_dwordx4 v[60:63], v1, s[32:35], s24 offen sc1
    buffer_load_dwordx4 v[64:67], v1, s[32:35], s25 offen sc1
    ds_read_b32 v13, v9 offset:11776
    ds_read_b32 v11, v246 offset:11280
    v_and_b32 v24, 0xffffff00, v24
    s_waitcnt lgkmcnt(0)
    v_and_b32 v13, 0xffff0000, v13
    v_add_u32 v7, v7, v11
    v_add_u32 v4, v4, v11
    v_xor_b32 v10, 0x2000, v4
    s_waitcnt vmcnt(7)
    v_perm_b32 v192, v130, v128, s56
    v_perm_b32 v193, v134, v132, s56
    v_perm_b32 v194, v138, v136, s56
    v_perm_b32 v195, v142, v140, s56
    v_perm_b32 v196, v146, v144, s56
    v_perm_b32 v197, v150, v148, s56
    v_perm_b32 v198, v154, v152, s56
    v_perm_b32 v199, v158, v156, s56
    v_perm_b32 v200, v130, v128, s60
    v_perm_b32 v201, v134, v132, s60
    v_perm_b32 v202, v138, v136, s60
    v_perm_b32 v203, v142, v140, s60
    v_perm_b32 v204, v146, v144, s60
    v_perm_b32 v205, v150, v148, s60
    v_perm_b32 v206, v154, v152, s60
    v_perm_b32 v207, v158, v156, s60
    v_perm_b32 v208, v131, v129, s56
    v_perm_b32 v209, v135, v133, s56
    v_perm_b32 v210, v139, v137, s56
    v_perm_b32 v211, v143, v141, s56
    v_perm_b32 v212, v147, v145, s56
    v_perm_b32 v213, v151, v149, s56
    v_perm_b32 v214, v155, v153, s56
    v_perm_b32 v215, v159, v157, s56
    v_perm_b32 v216, v131, v129, s60
    v_perm_b32 v217, v135, v133, s60
    v_perm_b32 v218, v139, v137, s60
    v_perm_b32 v219, v143, v141, s60
    v_perm_b32 v220, v147, v145, s60
    v_perm_b32 v221, v151, v149, s60
    v_perm_b32 v222, v155, v153, s60
    v_perm_b32 v223, v159, v157, s60
    s_branch L_chk29
L_poll28:
    s_sub_u32 s58, s58, 1
    s_cbranch_scc1 L_pdone30
    s_wqm_b64 exec, s[8:9]
    buffer_load_dwordx4 v[44:47], v1, s[32:35], s20 offen sc1
    s_wqm_b64 exec, s[10:11]
    buffer_load_dwordx4 v[48:51], v1, s[32:35], s21 offen sc1
    s_wqm_b64 exec, s[12:13]
    buffer_load_dwordx4 v[52:55], v1, s[32:35], s22 offen sc1
    s_wqm_b64 exec, s[14:15]
    buffer_load_dwordx4 v[56:59], v1, s[32:35], s23 offen sc1
    s_wqm_b64 exec, s[16:17]
    buffer_load_dwordx4 v[60:63], v1, s[32:35], s24 offen sc1
    s_wqm_b64 exec, s[18:19]
    buffer_load_dwordx4 v[64:67], v1, s[32:35], s25 offen sc1
    s_mov_b64 exec, -1
L_chk29:
    s_waitcnt vmcnt(5)
    v_cmp_ne_u32_sdwa s[8:9], v44, v244 src0_sel:BYTE_0 src1_sel:DWORD
    v_and_b32 v36, 0xffffff00, v44
    v_pk_add_f32 v[30:31], v[26:27], v[46:47]
    v_add_f32 v29, v25, v45
    v_add_f32 v28, v24, v36
    s_waitcnt vmcnt(4)
    v_cmp_ne_u32_sdwa s[10:11], v48, v244 src0_sel:BYTE_0 src1_sel:DWORD
    v_and_b32 v36, 0xffffff00, v48
    v_pk_add_f32 v[30:31], v[30:31], v[50:51]
    v_add_f32 v29, v29, v49
    v_add_f32 v28, v28, v36
    s_or_b64 vcc, s[8:9], s[10:11]
    s_waitcnt vmcnt(3)
    v_cmp_ne_u32_sdwa s[12:13], v52, v244 src0_sel:BYTE_0 src1_sel:DWORD
    v_and_b32 v36, 0xffffff00, v52
    v_pk_add_f32 v[30:31], v[30:31], v[54:55]
    v_add_f32 v29, v29, v53
    v_add_f32 v28, v28, v36
    s_or_b64 vcc, vcc, s[12:13]
    s_waitcnt vmcnt(2)
    v_cmp_ne_u32_sdwa s[14:15], v56, v244 src0_sel:BYTE_0 src1_sel:DWORD
    v_and_b32 v36, 0xffffff00, v56
    v_pk_add_f32 v[30:31], v[30:31], v[58:59]
    v_add_f32 v29, v29, v57
    v_add_f32 v28, v28, v36
    s_or_b64 vcc, vcc, s[14:15]
    s_waitcnt vmcnt(1)
    v_cmp_ne_u32_sdwa s[16:17], v60, v244 src0_sel:BYTE_0 src1_sel:DWORD
    v_and_b32 v36, 0xffffff00, v60
    v_pk_add_f32 v[30:31], v[30:31], v[62:63]
    v_add_f32 v29, v29, v61
    v_add_f32 v28, v28, v36
    s_or_b64 vcc, vcc, s[16:17]
    s_waitcnt vmcnt(0)
    v_cmp_ne_u32_sdwa s[18:19], v64, v244 src0_sel:BYTE_0 src1_sel:DWORD
    s_or_b64 vcc, vcc, s[18:19]
    s_cbranch_scc1 L_poll28
L_pdone30:
    s_barrier
    ds_read_b64 v[40:41], v246 offset:11288
    v_and_b32 v36, 0xffffff00, v64
    v_pk_add_f32 v[46:47], v[30:31], v[66:67]
    v_add_f32 v45, v29, v65
    v_add_f32 v44, v28, v36
    s_nop 0
    v_permlane32_swap_b32 v45, v47
    v_permlane32_swap_b32 v44, v46
    s_waitcnt lgkmcnt(0)
    v_pk_fma_f32 v[44:45], v[46:47], v[40:41], v[44:45] op_sel:[0,0,0] op_sel_hi:[1,0,1] neg_lo:[0,1,0] neg_hi:[0,1,0]
    v_pk_mul_f32 v[44:45], v[44:45], v[40:41] op_sel:[0,1] op_sel_hi:[1,1]
    v_cvt_pk_bf16_f32 v45, v44, v45
    s_nop 1
    v_mov_b32_dpp v46, v45 row_ror:8 row_mask:0xf bank_mask:0xf
    v_perm_b32 v44, v46, v45, v74
    v_perm_b32 v45, v46, v45, v75
    v_mul_f32 v46, v44, v44
    v_fmaak_f32 v46, v46, v76, 3222493025
    v_mul_f32 v46, v46, v44
    v_exp_f32 v46, v46
    s_nop 0
    v_add_f32 v46, 1.0, v46
    v_rcp_f32 v46, v46
    s_nop 0
    v_mul_f32 v46, v46, v44
    v_cvt_pk_bf16_f32 v46, v46, v46
    v_and_b32 v46, 0xffff0000, v46
    v_mul_f32 v46, v46, v45
    s_mov_b64 s[4:5], -1
    s_mov_b32 s6, 4294967295
    s_mov_b32 s7, 65535
    s_mov_b32 s58, 65536
    v_mov_b32_dpp v47, v46 quad_perm:[1,1,3,3] row_mask:0xf bank_mask:0xf
    v_cvt_pk_bf16_f32 v46, v46, v47
    s_nop 1
    v_mov_b32_dpp v116, v46 row_newbcast:0 row_mask:0xf bank_mask:0xf
    v_mov_b32_dpp v117, v46 row_newbcast:2 row_mask:0xf bank_mask:0xf
    v_mov_b32_dpp v118, v46 row_newbcast:4 row_mask:0xf bank_mask:0xf
    v_mov_b32_dpp v119, v46 row_newbcast:6 row_mask:0xf bank_mask:0xf
    v_mov_b32_dpp v120, v46 row_newbcast:8 row_mask:0xf bank_mask:0xf
    v_mov_b32_dpp v121, v46 row_newbcast:10 row_mask:0xf bank_mask:0xf
    v_mov_b32_dpp v122, v46 row_newbcast:12 row_mask:0xf bank_mask:0xf
    v_mov_b32_dpp v123, v46 row_newbcast:14 row_mask:0xf bank_mask:0xf
    v_mfma_f32_16x16x32_bf16 v[32:35], v[116:119], v[192:195], 0
    v_mfma_f32_16x16x32_bf16 v[36:39], v[116:119], v[200:203], 0
    v_mfma_f32_16x16x32_bf16 v[40:43], v[116:119], v[208:211], 0
    v_mfma_f32_16x16x32_bf16 v[44:47], v[116:119], v[216:219], 0
    v_mfma_f32_16x16x32_bf16 v[32:35], v[120:123], v[196:199], v[32:35]
    v_mfma_f32_16x16x32_bf16 v[36:39], v[120:123], v[204:207], v[36:39]
    v_mfma_f32_16x16x32_bf16 v[40:43], v[120:123], v[212:215], v[40:43]
    v_mfma_f32_16x16x32_bf16 v[44:47], v[120:123], v[220:223], v[44:47]
    s_nop 4
    v_bfi_b32 v32, v245, v244, v32
    v_mov_b32 v33, v36
    s_nop 0
    v_pk_mov_b32 v[34:35], v[40:41], v[44:45] op_sel:[0,0]
    buffer_store_dwordx4 v[32:35], v4, s[32:35], s49 offen sc1
    buffer_store_dwordx4 v[32:35], v10, s[32:35], s49 offen sc1
    s_cmp_gt_u32 s50, 3
    s_cbranch_scc1 L_Eend
    v_mov_b32 v80, 0
    v_mov_b32 v81, 0
    v_mov_b32 v82, 0
    v_mov_b32 v83, 0
    s_waitcnt vmcnt(1)
    s_mov_b64 exec, s[4:5]
    buffer_load_dwordx4 v[160:163], v7, s[32:35], s54 offen sc1
    s_mov_b64 exec, s[6:7]
    buffer_load_dwordx4 v[164:167], v7, s[32:35], s53 offen sc1
    s_mov_b64 exec, -1
    s_waitcnt vmcnt(2)
    s_mov_b64 exec, s[4:5]
    buffer_load_dwordx4 v[168:171], v7, s[32:35], s54 offen sc1
    s_mov_b64 exec, s[6:7]
    buffer_load_dwordx4 v[172:175], v7, s[32:35], s53 offen sc1
    s_mov_b64 exec, -1
L_ps37:
    s_waitcnt vmcnt(3)
    v_cmp_ne_u32_sdwa vcc, v160, v244 src0_sel:BYTE_0 src1_sel:DWORD
    v_and_b32 v160, 0xffffff00, v160
    s_wqm_b64 vcc, vcc
    s_andn2_b64 exec, s[4:5], vcc
    s_and_b64 s[4:5], s[4:5], vcc
    v_pk_add_f32 v[80:81], v[80:81], v[160:161]
    v_pk_add_f32 v[82:83], v[82:83], v[162:163]
    s_mov_b64 exec, -1
    s_waitcnt vmcnt(2)
    v_cmp_ne_u32_sdwa vcc, v164, v244 src0_sel:BYTE_0 src1_sel:DWORD
    v_and_b32 v164, 0xffffff00, v164
    s_wqm_b64 vcc, vcc
    s_andn2_b64 exec, s[6:7], vcc
    s_and_b64 s[6:7], s[6:7], vcc
    v_pk_add_f32 v[80:81], v[80:81], v[164:165]
    v_pk_add_f32 v[82:83], v[82:83], v[166:167]
    s_mov_b64 exec, -1
    s_or_b64 vcc, s[4:5], s[6:7]
    s_cbranch_scc0 L_psd38
    s_mov_b64 exec, s[4:5]
    buffer_load_dwordx4 v[160:163], v7, s[32:35], s54 offen sc1
    s_mov_b64 exec, s[6:7]
    buffer_load_dwordx4 v[164:167], v7, s[32:35], s53 offen sc1
    s_mov_b64 exec, -1
    s_waitcnt vmcnt(3)
    v_cmp_ne_u32_sdwa vcc, v168, v244 src0_sel:BYTE_0 src1_sel:DWORD
    v_and_b32 v168, 0xffffff00, v168
    s_wqm_b64 vcc, vcc
    s_andn2_b64 exec, s[4:5], vcc
    s_and_b64 s[4:5], s[4:5], vcc
    v_pk_add_f32 v[80:81], v[80:81], v[168:169]
    v_pk_add_f32 v[82:83], v[82:83], v[170:171]
    s_mov_b64 exec, -1
    s_waitcnt vmcnt(2)
    v_cmp_ne_u32_sdwa vcc, v172, v244 src0_sel:BYTE_0 src1_sel:DWORD
    v_and_b32 v172, 0xffffff00, v172
    s_wqm_b64 vcc, vcc
    s_andn2_b64 exec, s[6:7], vcc
    s_and_b64 s[6:7], s[6:7], vcc
    v_pk_add_f32 v[80:81], v[80:81], v[172:173]
    v_pk_add_f32 v[82:83], v[82:83], v[174:175]
    s_mov_b64 exec, -1
    s_or_b64 vcc, s[4:5], s[6:7]
    s_cbranch_scc0 L_psd38
    s_mov_b64 exec, s[4:5]
    buffer_load_dwordx4 v[168:171], v7, s[32:35], s54 offen sc1
    s_mov_b64 exec, s[6:7]
    buffer_load_dwordx4 v[172:175], v7, s[32:35], s53 offen sc1
    s_mov_b64 exec, -1
    s_sub_u32 s58, s58, 1
    s_cbranch_scc0 L_ps37
L_psd38:
    v_permlane32_swap_b32 v80, v82
    v_permlane32_swap_b32 v81, v83
    v_add_f32 v80, v80, v82
    v_add_f32 v81, v81, v83
    s_nop 1
    v_permlane16_swap_b32 v80, v81
    v_add_f32 v80, v80, v81
    s_nop 1
    v_add_f32_dpp v80, v80, v80 row_ror:4 row_mask:0xf bank_mask:0xf
    s_nop 1
    v_add_f32_dpp v80, v80, v80 row_ror:8 row_mask:0xf bank_mask:0xf
    v_cvt_pk_bf16_f32 v80, v80, v80
    v_and_b32 v80, 0xffff0000, v80
    v_add_f32 v80, v80, v13
    v_cvt_pk_bf16_f32 v80, v80, v80
    buffer_store_short v80, v8, s[40:43], s55 offen
L_Eend:
    s_endpgm
L_wb4:
L_far1:
    s_nop 7
    buffer_store_dwordx4 v[12:15], v229, s[32:35], s53 offen sc1
    s_nop 1
    s_branch L_back2
L_far16:
    s_nop 7
    buffer_store_dword v17, v235, s[32:35], s62 offen sc1
    s_nop 1
    s_branch L_back17
L_qfar:
    s_nop 7
    buffer_store_dwordx4 v[8:11], v71, s[32:35], s3 offen sc1
    s_nop 1
    s_branch L_qnear
L_far23:
    s_nop 7
    buffer_store_dwordx4 v[8:11], v14, s[32:35], s60 offen sc1
    s_nop 1
    s_branch L_back24
L_far26:
    s_nop 7
    buffer_store_dwordx4 v[24:27], v1, s[32:35], s62 offen sc1
    s_nop 1
    s_branch L_back27
L_exit:
    s_endpgm
.section .rodata,"a"
.p2align 6
.amdhsa_kernel sequential_preLN__sliding_block_cached__geglu_ffn__decode_kernel
  .amdhsa_next_free_vgpr 256
  .amdhsa_next_free_sgpr 102
  .amdhsa_accum_offset 256
  .amdhsa_group_segment_fixed_size 0
  .amdhsa_kernarg_size 96
  .amdhsa_user_sgpr_count 2
  .amdhsa_user_sgpr_kernarg_segment_ptr 1
  .amdhsa_system_sgpr_workgroup_id_x 1
.end_amdhsa_kernel
```
